```python
import torch

def _softmax(x, axis=-1):
    return torch.softmax(x, dim=axis)
def _gelu(x):
    return torch.nn.functional.gelu(x, approximate="tanh")
def _silu(x):
    return torch.nn.functional.silu(x)
def _sigmoid(x):
    return torch.sigmoid(x)
def _layernorm(x, axis=-1, eps=1e-5):
    m = x.mean(dim=axis, keepdim=True)
    v = x.var(dim=axis, keepdim=True, unbiased=False)
    return (x - m) / torch.sqrt(v + eps)
def _scatter_add(tgt, idx, src, axis=0):
    return tgt.clone().index_add_(axis, idx, src)
def _segment_sum(src, seg, n):
    out = torch.zeros((n,) + src.shape[1:], dtype=src.dtype)
    return out.index_add_(0, seg, src)
def _pad(x, pw):
    flat = tuple(v for pair in reversed(pw) for v in pair)
    return torch.nn.functional.pad(x, flat)

kernel_name = 'parallel_sum__sliding_block_cached__mixer_channel_mlp__decode'

def setup_inputs():

    _w = (lambda a: (lambda t: t.to(torch.bfloat16) if t.is_floating_point() else t)(torch.as_tensor(a)))
    def _A_setup():
        B, Sq, D = 1, 1, 576
        Hq, Hkv, Sk, Dh = 32, 16, 16384, 128
        assert Hq % Hkv == 0, (Hq, Hkv)
        return {
            "x": _w((lambda *s: torch.randn(*s, dtype=torch.bfloat16) * 0.05)(B, Sq, D)),
            "k_cache": _w((lambda *s: torch.randn(*s, dtype=torch.bfloat16) * 3.2)(B, Hkv, Sk, Dh)),
            "v_cache": _w((lambda *s: torch.randn(*s, dtype=torch.bfloat16) * 0.4)(B, Hkv, Sk, Dh)),
            "wq": _w((lambda *s: torch.randn(*s, dtype=torch.bfloat16) * 3.2)(D, Hq * Dh) * (D ** -0.5)),
            "wo": _w((lambda *s: torch.randn(*s, dtype=torch.bfloat16) * 0.4)(Hq * Dh, D) * ((Hq * Dh) ** -0.5)),
        }
    _A_in = _A_setup()

    def _B_setup():
        B, S, D, F = 1, 1, 576, 4608
        return {
            "x": _w((lambda *s: torch.randn(*s, dtype=torch.bfloat16) * 0.05)(B, S, D)),
            "w1": _w((lambda *s: torch.randn(*s, dtype=torch.bfloat16) * 3.2)(D, F) * (D ** -0.5)),
            "b1": _w((lambda *s: torch.randn(*s, dtype=torch.bfloat16) * 1.6)(F)),
            "w2": _w((lambda *s: torch.randn(*s, dtype=torch.bfloat16) * 0.1)(F, D) * (F ** -0.5)),
            "b2": _w((lambda *s: torch.randn(*s, dtype=torch.bfloat16) * 0.1)(D)),
        }
    _B_in = _B_setup()

    return {
        "A_x": _A_in["x"],
        "A_k_cache": _A_in["k_cache"],
        "A_v_cache": _A_in["v_cache"],
        "A_wq": _A_in["wq"],
        "A_wo": _A_in["wo"],
        "B_x": _B_in["x"],
        "B_w1": _B_in["w1"],
        "B_b1": _B_in["b1"],
        "B_w2": _B_in["w2"],
        "B_b2": _B_in["b2"],
    }

def reference(A_x, A_k_cache, A_v_cache, A_wq, A_wo, B_x, B_w1, B_b1, B_w2, B_b2):
    def _A_ref(x, k_cache, v_cache, wq, wo):
        B, Sq, D = x.shape
        Hq, Dh = 32, 128
        Hkv, Sk = k_cache.shape[1], k_cache.shape[2]
        W = min(4096, max(256, Sk // 4))
        rep = Hq // Hkv
        q = (lambda x, *d: x.permute(*d))((x @ wq).reshape(B, Sq, Hq, Dh), 0, 2, 1, 3)
        k = (lambda x, n, axis: torch.repeat_interleave(x, n, dim=axis))(k_cache[:, :, Sk - W:, :], rep, axis=1)
        v = (lambda x, n, axis: torch.repeat_interleave(x, n, dim=axis))(v_cache[:, :, Sk - W:, :], rep, axis=1)
        scores = torch.einsum("bhqd,bhkd->bhqk", q, k) * (Dh ** -0.5)
        p = _softmax(scores, axis=-1)
        o = torch.einsum("bhqk,bhkd->bhqd", p, v)
        return (lambda x, *d: x.permute(*d))(o, 0, 2, 1, 3).reshape(B, Sq, Hq * Dh) @ wo

    def _B_ref(x, w1, b1, w2, b2):
        y = _layernorm(x, axis=-1)
        h = _gelu(torch.einsum("bsd,df->bsf", y, w1) + b1)
        return torch.einsum("bsf,fd->bsd", h, w2) + b2

    x = A_x
    xn = _layernorm(x, axis=-1)
    return x + _A_ref(xn, A_k_cache, A_v_cache, A_wq, A_wo) + _B_ref(xn, B_w1, B_b1, B_w2, B_b2)
```

```asm
; @launch grid=(256,1,1) block=(896,1,1) lds=14336
.amdgcn_target "amdgcn-amd-amdhsa--gfx950"
.text
.globl parallel_sum__sliding_block_cached__mixer_channel_mlp__decode_kernel
.p2align 8
.type parallel_sum__sliding_block_cached__mixer_channel_mlp__decode_kernel,@function
parallel_sum__sliding_block_cached__mixer_channel_mlp__decode_kernel:
    s_cmpk_lt_u32 s2, 0x100
    s_cbranch_scc0 L_end
    s_nop 0
    s_load_dwordx16 s[8:23], s[0:1], 0
    s_load_dwordx8 s[24:31], s[0:1], 64
    s_load_dwordx2 s[32:33], s[0:1], 96
    v_readfirstlane_b32 s3, v0
    v_and_b32 v1, 63, v0
    v_lshlrev_b32 v2, 4, v0
    v_mov_b64 v[4:5], 0
    v_mov_b64 v[6:7], 0
    s_and_b32 s6, s2, 7
    s_bfe_u32 s7, s2, 0x10003

    s_lshr_b32 s3, s3, 6
    ds_write_b128 v2, v[4:7]
    s_lshl1_add_u32 s4, s6, s7
    s_lshr_b32 s5, s2, 4
    s_lshr_b32 s7, s2, 3
    s_mov_b32 s39, 0x20000
    v_lshlrev_b32 v2, 4, v1
    s_sub_u32 s35, s3, 1
    s_cbranch_scc1 L_Qstub
    s_and_b32 s60, s35, 3
    s_lshl_b32 s56, s4, 8
    s_lshl2_add_u32 s57, s5, s60
    s_add_u32 s56, s56, s57
    s_add_u32 s56, s56, 192
    s_add_u32 s61, s60, s5
    s_and_b32 s61, s61, 3
    s_lshl2_add_u32 s56, s56, s61
    s_lshl_b32 s56, s56, 12
    s_mov_b32 s38, 0x4000000
    s_cmp_lt_u32 s35, 4
    s_cbranch_scc0 L_notK

    s_setprio 2
    s_xor_b32 s57, s56, 4096
    s_waitcnt lgkmcnt(0)
    s_mov_b64 s[36:37], s[10:11]

    buffer_load_dwordx4 v[16:19], v2, s[36:39], s56 offen offset:0 nt
    buffer_load_dwordx4 v[20:23], v2, s[36:39], s56 offen offset:1024 nt
    buffer_load_dwordx4 v[24:27], v2, s[36:39], s56 offen offset:2048 nt
    buffer_load_dwordx4 v[28:31], v2, s[36:39], s56 offen offset:3072 nt
    s_branch L_Kbody
L_Qstub:
    s_setprio 3
    s_getpc_b64 s[44:45]
L_pc:
    s_mov_b32 s46, L_codeend-L_pc
    s_mov_b32 s47, 0x20000
    v_lshlrev_b32 v5, 7, v1

    s_movk_i32 s48, 0
    buffer_load_dword v100, v5, s[44:47], s48 offen
    s_movk_i32 s48, 8192
    buffer_load_dword v101, v5, s[44:47], s48 offen
    v_lshrrev_b32 v3, 3, v1
    v_and_b32 v4, 7, v1
    v_lshlrev_b32 v127, 1, v1
    s_movk_i32 s42, 1152
    s_mov_b32 s43, 0x20000
    v_lshlrev_b32 v4, 4, v4
    v_lshl_or_b32 v5, v3, 17, v4
    v_lshl_or_b32 v6, v3, 14, v4

    s_lshr_b32 s60, s5, 2
    s_add_u32 s61, s5, 0
    s_and_b32 s61, s61, 3
    s_mov_b32 s63, s4

    s_mul_i32 s44, s60, 1179648
    s_lshl_b32 s45, s63, 9
    s_add_u32 s44, s44, s45
    s_lshl_b32 s45, s61, 7
    s_add_u32 s44, s44, s45

    s_add_u32 s45, s44, 8192
    s_add_u32 s46, s44, 16384
    s_add_u32 s47, s44, 24576
    s_add_u32 s48, s44, 32768
    s_add_u32 s49, s44, 40960
    s_add_u32 s50, s44, 49152
    s_add_u32 s51, s44, 57344
    s_add_u32 s52, s44, 65536
    s_add_u32 s53, s44, 73728
    s_add_u32 s54, s44, 81920
    s_add_u32 s55, s44, 90112
    s_add_u32 s56, s44, 98304
    s_add_u32 s57, s44, 106496
    s_add_u32 s58, s44, 114688
    s_add_u32 s59, s44, 122880
    s_mov_b32 s38, 4718592
    s_waitcnt lgkmcnt(0)
    s_mov_b64 s[40:41], s[8:9]
    s_mov_b64 s[36:37], s[14:15]

    buffer_load_dwordx4 v[120:123], v2, s[40:43], 0 offen
    buffer_load_ushort v124, v127, s[40:43], 0 offen offset:1024

    v_mov_b32 v2, v5
    v_mov_b32 v0, v6
    s_add_u32 s18, s44, 1048576
    s_add_u32 s19, s44, 1056768
    buffer_load_dwordx4 v[16:19], v2, s[36:39], s44 offen nt
    buffer_load_dwordx4 v[20:23], v2, s[36:39], s45 offen nt
    buffer_load_dwordx4 v[24:27], v2, s[36:39], s46 offen nt
    buffer_load_dwordx4 v[28:31], v2, s[36:39], s47 offen nt
    buffer_load_dwordx4 v[32:35], v2, s[36:39], s48 offen nt
    buffer_load_dwordx4 v[36:39], v2, s[36:39], s49 offen nt
    buffer_load_dwordx4 v[40:43], v2, s[36:39], s50 offen nt
    buffer_load_dwordx4 v[44:47], v2, s[36:39], s51 offen nt
    buffer_load_dwordx4 v[48:51], v2, s[36:39], s52 offen nt
    buffer_load_dwordx4 v[52:55], v2, s[36:39], s53 offen nt
    buffer_load_dwordx4 v[56:59], v2, s[36:39], s54 offen nt
    buffer_load_dwordx4 v[60:63], v2, s[36:39], s55 offen nt
    buffer_load_dwordx4 v[64:67], v2, s[36:39], s56 offen nt
    buffer_load_dwordx4 v[68:71], v2, s[36:39], s57 offen nt
    buffer_load_dwordx4 v[72:75], v2, s[36:39], s58 offen nt
    buffer_load_dwordx4 v[76:79], v2, s[36:39], s59 offen nt
    buffer_load_dwordx4 v[80:83], v0, s[36:39], s18 offen nt
    buffer_load_dwordx4 v[84:87], v0, s[36:39], s19 offen nt
    s_load_dword s73, s[32:33], 0
    s_branch L_Qbody

L_notK:
    s_mov_b32 s43, 0x20000
    s_cmp_lt_u32 s3, 10
    s_cbranch_scc1 L_notV
    s_waitcnt lgkmcnt(0)
    s_mov_b64 s[36:37], s[12:13]

    buffer_load_dwordx4 v[16:19], v2, s[36:39], s56 offen offset:0 nt
    s_branch L_Vbody
L_notV:
    v_lshrrev_b32 v3, 3, v1
    v_and_b32 v4, 7, v1
    s_cmp_lt_u32 s3, 7
    s_cbranch_scc1 L_notW
    v_lshlrev_b32 v4, 4, v4
    v_lshrrev_b32 v12, 5, v1
    v_bfe_u32 v13, v1, 3, 1
    v_bfe_u32 v14, v1, 4, 1
    v_lshl_or_b32 v7, v12, 7, v4
    v_lshl_or_b32 v7, v13, 8, v7
    v_mov_b32 v15, 0x80000000
    v_cmp_gt_u32 vcc, 0x180, v7
    s_sub_u32 s3, s3, 7
    s_mul_i32 s60, s3, 384
    v_cndmask_b32 v7, v15, v7, vcc
    v_mul_u32_u24 v6, 9216, v14
    v_mul_u32_u24 v8, 1152, v14
    v_mul_u32_u24 v5, 18432, v3
    v_mul_u32_u24 v9, 2304, v3
    v_add_u32 v6, v6, v7
    v_add_u32 v8, v8, v7
    v_add_u32 v5, v5, v4
    v_add_u32 v9, v9, v4
    s_mul_i32 s56, s7, 165888
    s_mul_i32 s57, s6, 1152
    s_add_u32 s56, s56, s57
    s_add_u32 s56, s56, s60
    s_add_u32 s57, s56, 9216
    s_add_u32 s59, s56, 147456
    s_lshl_b32 s64, s6, 5
    s_add_u32 s62, s64, s7
    s_mul_i32 s64, s62, 20736
    s_add_u32 s64, s64, s60
    s_add_u32 s66, s64, 18432
    s_lshl_b32 s67, s4, 4
    s_add_u32 s67, s67, s5
    s_mul_i32 s67, s67, 18432
    s_add_u32 s67, s67, s60
    s_mov_b32 s38, 5308416
    s_mov_b32 s46, 5308416
    s_mov_b32 s47, 0x20000
    s_mov_b32 s50, 4718592
    s_mov_b32 s51, 0x20000
    s_waitcnt lgkmcnt(0)
    s_mov_b64 s[36:37], s[20:21]
    s_mov_b64 s[44:45], s[24:25]
    s_mov_b64 s[48:49], s[16:17]
    s_load_dword s73, s[32:33], 0

    buffer_load_dwordx4 v[40:43], v6, s[36:39], s59 offen nt
    buffer_load_dwordx4 v[44:47], v8, s[44:47], s66 offen nt
    s_mov_b64 exec, 1
    buffer_load_dword v48, off, s[48:51], s67 nt
    s_mov_b64 exec, -1
    buffer_load_dwordx4 v[16:19], v5, s[36:39], s56 offen offset:0 nt
    buffer_load_dwordx4 v[20:23], v5, s[36:39], s56 offen offset:128 nt
    buffer_load_dwordx4 v[24:27], v5, s[36:39], s56 offen offset:256 nt
    s_branch L_Wbody
L_notW:
    s_cmp_eq_u32 s3, 6
    s_cbranch_scc1 L_Rbody
    s_setprio 3
    v_lshlrev_b32 v127, 1, v1
    s_movk_i32 s42, 1152
    s_waitcnt lgkmcnt(0)
    s_mov_b64 s[40:41], s[8:9]
    s_nop 0

    s_load_dword s73, s[32:33], 0
    v_mov_b32 v11, 0
    s_barrier
    s_mov_b64 s[40:41], s[32:33]
    s_mov_b32 s42, 0x10000000
    v_mov_b32 v125, 0x3ae38e39
    v_lshlrev_b32 v126, 5, v1
    v_lshlrev_b32 v127, 2, v1

    s_movk_i32 s34, 16384
L_w_1:
    ds_read_b32 v8, v11 offset:12
    ds_read_b128 v[98:101], v126 offset:1536
    ds_read_b128 v[102:105], v126 offset:1552
    ds_read_b32 v106, v127 offset:3584
    s_waitcnt lgkmcnt(0)
    v_cmp_ne_u32 vcc, 1, v8
    s_sub_u32 s34, s34, 1
    s_cbranch_scc1 L_d_2
    s_cbranch_vccnz L_w_1
L_d_2:

    s_branch L_S1
L_Kbody:
    s_xor_b32 s58, s56, 8192
    s_xor_b32 s59, s56, 12288
    s_lshl_b32 s61, s60, 2
    v_mov_b32 v10, s61
    v_mov_b32 v11, 1
    v_mov_b32 v6, 0
    s_barrier

    s_waitcnt vmcnt(3)
    buffer_load_dwordx4 v[32:35], v2, s[36:39], s57 offen offset:0 nt
    s_waitcnt vmcnt(3)
    buffer_load_dwordx4 v[36:39], v2, s[36:39], s57 offen offset:1024 nt
    s_waitcnt vmcnt(3)
    buffer_load_dwordx4 v[40:43], v2, s[36:39], s57 offen offset:2048 nt
    s_waitcnt vmcnt(3)
    buffer_load_dwordx4 v[44:47], v2, s[36:39], s57 offen offset:3072 nt
    s_waitcnt vmcnt(3)
    buffer_load_dwordx4 v[48:51], v2, s[36:39], s58 offen offset:0 nt
    s_mov_b64 exec, 1
    ds_add_u32 v6, v11 offset:116
    s_mov_b64 exec, -1
    s_waitcnt vmcnt(3)
    buffer_load_dwordx4 v[52:55], v2, s[36:39], s58 offen offset:1024 nt
    s_waitcnt vmcnt(3)
    buffer_load_dwordx4 v[56:59], v2, s[36:39], s58 offen offset:2048 nt
    s_waitcnt vmcnt(3)
    buffer_load_dwordx4 v[60:63], v2, s[36:39], s58 offen offset:3072 nt
    s_waitcnt vmcnt(3)
    buffer_load_dwordx4 v[64:67], v2, s[36:39], s59 offen offset:0 nt
    s_waitcnt vmcnt(3)
    buffer_load_dwordx4 v[68:71], v2, s[36:39], s59 offen offset:1024 nt
    s_waitcnt vmcnt(3)
    buffer_load_dwordx4 v[72:75], v2, s[36:39], s59 offen offset:2048 nt
    s_waitcnt vmcnt(3)
    buffer_load_dwordx4 v[76:79], v2, s[36:39], s59 offen offset:3072 nt
    ds_write_b32 v10, v11 offset:64
    s_setprio 0
    v_and_b32 v7, 15, v1
    v_lshlrev_b32 v7, 4, v7
    v_lshrrev_b32 v14, 2, v1
    s_lshl_b32 s61, s60, 9
    v_lshl_add_u32 v14, v14, 5, s61
    v_and_b32 v15, 8, v1
    s_lshl_b32 s61, s60, 3
    v_lshl_add_u32 v15, v15, 2, s61
    s_mov_b32 s62, 0x11111111
    s_mov_b32 s63, 0x11111111

    s_movk_i32 s34, 16384
L_w_3:
    ds_read_b32 v8, v6 offset:8
    ds_read_b128 v[80:83], v7 offset:1024
    ds_read_b128 v[84:87], v7 offset:1280
    s_waitcnt lgkmcnt(0)
    v_cmp_ne_u32 vcc, 1, v8
    s_sub_u32 s34, s34, 1
    s_cbranch_scc1 L_d_4
    s_cbranch_vccnz L_w_3
L_d_4:

    s_setprio 1
    v_dot2_f32_bf16 v88, v16, v80, 0
    v_dot2_f32_bf16 v104, v16, v84, 0
    v_dot2_f32_bf16 v89, v20, v80, 0
    v_dot2_f32_bf16 v105, v20, v84, 0
    v_dot2_f32_bf16 v90, v24, v80, 0
    v_dot2_f32_bf16 v106, v24, v84, 0
    v_dot2_f32_bf16 v91, v28, v80, 0
    v_dot2_f32_bf16 v107, v28, v84, 0
    v_dot2c_f32_bf16 v88, v17, v81
    v_dot2c_f32_bf16 v104, v17, v85
    v_dot2c_f32_bf16 v89, v21, v81
    v_dot2c_f32_bf16 v105, v21, v85
    v_dot2c_f32_bf16 v90, v25, v81
    v_dot2c_f32_bf16 v106, v25, v85
    v_dot2c_f32_bf16 v91, v29, v81
    v_dot2c_f32_bf16 v107, v29, v85
    v_dot2c_f32_bf16 v88, v18, v82
    v_dot2c_f32_bf16 v104, v18, v86
    v_dot2c_f32_bf16 v89, v22, v82
    v_dot2c_f32_bf16 v105, v22, v86
    v_dot2c_f32_bf16 v90, v26, v82
    v_dot2c_f32_bf16 v106, v26, v86
    v_dot2c_f32_bf16 v91, v30, v82
    v_dot2c_f32_bf16 v107, v30, v86
    v_dot2c_f32_bf16 v88, v19, v83
    v_dot2c_f32_bf16 v104, v19, v87
    v_dot2c_f32_bf16 v89, v23, v83
    v_dot2c_f32_bf16 v105, v23, v87
    v_dot2c_f32_bf16 v90, v27, v83
    v_dot2c_f32_bf16 v106, v27, v87
    v_dot2c_f32_bf16 v91, v31, v83
    v_dot2c_f32_bf16 v107, v31, v87
    v_dot2_f32_bf16 v92, v32, v80, 0
    v_dot2_f32_bf16 v108, v32, v84, 0
    v_dot2_f32_bf16 v93, v36, v80, 0
    v_dot2_f32_bf16 v109, v36, v84, 0
    v_dot2_f32_bf16 v94, v40, v80, 0
    v_dot2_f32_bf16 v110, v40, v84, 0
    v_dot2_f32_bf16 v95, v44, v80, 0
    v_dot2_f32_bf16 v111, v44, v84, 0
    v_add_f32_dpp v88, v88, v88 row_ror:8 row_mask:0xf bank_mask:0x3
    v_add_f32_dpp v89, v89, v89 row_ror:8 row_mask:0xf bank_mask:0x3
    v_add_f32_dpp v90, v90, v90 row_ror:8 row_mask:0xf bank_mask:0x3
    v_add_f32_dpp v91, v91, v91 row_ror:8 row_mask:0xf bank_mask:0x3
    v_add_f32_dpp v88, v104, v104 row_ror:8 row_mask:0xf bank_mask:0xc
    v_add_f32_dpp v89, v105, v105 row_ror:8 row_mask:0xf bank_mask:0xc
    v_add_f32_dpp v90, v106, v106 row_ror:8 row_mask:0xf bank_mask:0xc
    v_add_f32_dpp v91, v107, v107 row_ror:8 row_mask:0xf bank_mask:0xc
    v_dot2c_f32_bf16 v92, v33, v81
    v_dot2c_f32_bf16 v108, v33, v85
    v_dot2c_f32_bf16 v93, v37, v81
    v_dot2c_f32_bf16 v109, v37, v85
    v_dot2c_f32_bf16 v94, v41, v81
    v_dot2c_f32_bf16 v110, v41, v85
    v_dot2c_f32_bf16 v95, v45, v81
    v_dot2c_f32_bf16 v111, v45, v85
    v_dot2c_f32_bf16 v92, v34, v82
    v_dot2c_f32_bf16 v108, v34, v86
    v_dot2c_f32_bf16 v93, v38, v82
    v_dot2c_f32_bf16 v109, v38, v86
    v_dot2c_f32_bf16 v94, v42, v82
    v_dot2c_f32_bf16 v110, v42, v86
    v_dot2c_f32_bf16 v95, v46, v82
    v_dot2c_f32_bf16 v111, v46, v86
    v_dot2c_f32_bf16 v92, v35, v83
    v_dot2c_f32_bf16 v108, v35, v87
    v_dot2c_f32_bf16 v93, v39, v83
    v_dot2c_f32_bf16 v109, v39, v87
    v_dot2c_f32_bf16 v94, v43, v83
    v_dot2c_f32_bf16 v110, v43, v87
    v_dot2c_f32_bf16 v95, v47, v83
    v_dot2c_f32_bf16 v111, v47, v87
    v_dot2_f32_bf16 v96, v48, v80, 0
    v_dot2_f32_bf16 v112, v48, v84, 0
    v_dot2_f32_bf16 v97, v52, v80, 0
    v_dot2_f32_bf16 v113, v52, v84, 0
    v_dot2_f32_bf16 v98, v56, v80, 0
    v_dot2_f32_bf16 v114, v56, v84, 0
    v_dot2_f32_bf16 v99, v60, v80, 0
    v_dot2_f32_bf16 v115, v60, v84, 0
    v_add_f32_dpp v92, v92, v92 row_ror:8 row_mask:0xf bank_mask:0x3
    v_add_f32_dpp v93, v93, v93 row_ror:8 row_mask:0xf bank_mask:0x3
    v_add_f32_dpp v94, v94, v94 row_ror:8 row_mask:0xf bank_mask:0x3
    v_add_f32_dpp v95, v95, v95 row_ror:8 row_mask:0xf bank_mask:0x3
    v_add_f32_dpp v92, v108, v108 row_ror:8 row_mask:0xf bank_mask:0xc
    v_add_f32_dpp v93, v109, v109 row_ror:8 row_mask:0xf bank_mask:0xc
    v_add_f32_dpp v94, v110, v110 row_ror:8 row_mask:0xf bank_mask:0xc
    v_add_f32_dpp v95, v111, v111 row_ror:8 row_mask:0xf bank_mask:0xc
    v_dot2c_f32_bf16 v96, v49, v81
    v_dot2c_f32_bf16 v112, v49, v85
    v_dot2c_f32_bf16 v97, v53, v81
    v_dot2c_f32_bf16 v113, v53, v85
    v_dot2c_f32_bf16 v98, v57, v81
    v_dot2c_f32_bf16 v114, v57, v85
    v_dot2c_f32_bf16 v99, v61, v81
    v_dot2c_f32_bf16 v115, v61, v85
    v_dot2c_f32_bf16 v96, v50, v82
    v_dot2c_f32_bf16 v112, v50, v86
    v_dot2c_f32_bf16 v97, v54, v82
    v_dot2c_f32_bf16 v113, v54, v86
    v_dot2c_f32_bf16 v98, v58, v82
    v_dot2c_f32_bf16 v114, v58, v86
    v_dot2c_f32_bf16 v99, v62, v82
    v_dot2c_f32_bf16 v115, v62, v86
    v_dot2c_f32_bf16 v96, v51, v83
    v_dot2c_f32_bf16 v112, v51, v87
    v_dot2c_f32_bf16 v97, v55, v83
    v_dot2c_f32_bf16 v113, v55, v87
    v_dot2c_f32_bf16 v98, v59, v83
    v_dot2c_f32_bf16 v114, v59, v87
    v_dot2c_f32_bf16 v99, v63, v83
    v_dot2c_f32_bf16 v115, v63, v87
    s_waitcnt vmcnt(0)
    v_dot2_f32_bf16 v100, v64, v80, 0
    v_dot2_f32_bf16 v116, v64, v84, 0
    v_dot2_f32_bf16 v101, v68, v80, 0
    v_dot2_f32_bf16 v117, v68, v84, 0
    v_dot2_f32_bf16 v102, v72, v80, 0
    v_dot2_f32_bf16 v118, v72, v84, 0
    v_dot2_f32_bf16 v103, v76, v80, 0
    v_dot2_f32_bf16 v119, v76, v84, 0
    v_add_f32_dpp v96, v96, v96 row_ror:8 row_mask:0xf bank_mask:0x3
    v_add_f32_dpp v97, v97, v97 row_ror:8 row_mask:0xf bank_mask:0x3
    v_add_f32_dpp v98, v98, v98 row_ror:8 row_mask:0xf bank_mask:0x3
    v_add_f32_dpp v99, v99, v99 row_ror:8 row_mask:0xf bank_mask:0x3
    v_add_f32_dpp v96, v112, v112 row_ror:8 row_mask:0xf bank_mask:0xc
    v_add_f32_dpp v97, v113, v113 row_ror:8 row_mask:0xf bank_mask:0xc
    v_add_f32_dpp v98, v114, v114 row_ror:8 row_mask:0xf bank_mask:0xc
    v_add_f32_dpp v99, v115, v115 row_ror:8 row_mask:0xf bank_mask:0xc
    v_dot2c_f32_bf16 v100, v65, v81
    v_dot2c_f32_bf16 v116, v65, v85
    v_dot2c_f32_bf16 v101, v69, v81
    v_dot2c_f32_bf16 v117, v69, v85
    v_dot2c_f32_bf16 v102, v73, v81
    v_dot2c_f32_bf16 v118, v73, v85
    v_dot2c_f32_bf16 v103, v77, v81
    v_dot2c_f32_bf16 v119, v77, v85
    v_dot2c_f32_bf16 v100, v66, v82
    v_dot2c_f32_bf16 v116, v66, v86
    v_dot2c_f32_bf16 v101, v70, v82
    v_dot2c_f32_bf16 v117, v70, v86
    v_dot2c_f32_bf16 v102, v74, v82
    v_dot2c_f32_bf16 v118, v74, v86
    v_dot2c_f32_bf16 v103, v78, v82
    v_dot2c_f32_bf16 v119, v78, v86
    v_dot2c_f32_bf16 v100, v67, v83
    v_dot2c_f32_bf16 v116, v67, v87
    v_dot2c_f32_bf16 v101, v71, v83
    v_dot2c_f32_bf16 v117, v71, v87
    v_dot2c_f32_bf16 v102, v75, v83
    v_dot2c_f32_bf16 v118, v75, v87
    v_dot2c_f32_bf16 v103, v79, v83
    v_dot2c_f32_bf16 v119, v79, v87
    v_add_f32_dpp v100, v100, v100 row_ror:8 row_mask:0xf bank_mask:0x3
    v_add_f32_dpp v101, v101, v101 row_ror:8 row_mask:0xf bank_mask:0x3
    v_add_f32_dpp v102, v102, v102 row_ror:8 row_mask:0xf bank_mask:0x3
    v_add_f32_dpp v103, v103, v103 row_ror:8 row_mask:0xf bank_mask:0x3
    v_add_f32_dpp v100, v116, v116 row_ror:8 row_mask:0xf bank_mask:0xc
    v_add_f32_dpp v101, v117, v117 row_ror:8 row_mask:0xf bank_mask:0xc
    v_add_f32_dpp v102, v118, v118 row_ror:8 row_mask:0xf bank_mask:0xc
    v_add_f32_dpp v103, v119, v119 row_ror:8 row_mask:0xf bank_mask:0xc
    v_add_f32_dpp v88, v88, v88 row_half_mirror row_mask:0xf bank_mask:0x5
    v_add_f32_dpp v89, v89, v89 row_half_mirror row_mask:0xf bank_mask:0x5
    v_add_f32_dpp v90, v90, v90 row_half_mirror row_mask:0xf bank_mask:0x5
    v_add_f32_dpp v91, v91, v91 row_half_mirror row_mask:0xf bank_mask:0x5
    v_add_f32_dpp v92, v92, v92 row_half_mirror row_mask:0xf bank_mask:0x5
    v_add_f32_dpp v93, v93, v93 row_half_mirror row_mask:0xf bank_mask:0x5
    v_add_f32_dpp v94, v94, v94 row_half_mirror row_mask:0xf bank_mask:0x5
    v_add_f32_dpp v95, v95, v95 row_half_mirror row_mask:0xf bank_mask:0x5
    v_add_f32_dpp v88, v96, v96 row_half_mirror row_mask:0xf bank_mask:0xa
    v_add_f32_dpp v89, v97, v97 row_half_mirror row_mask:0xf bank_mask:0xa
    v_add_f32_dpp v90, v98, v98 row_half_mirror row_mask:0xf bank_mask:0xa
    v_add_f32_dpp v91, v99, v99 row_half_mirror row_mask:0xf bank_mask:0xa
    v_add_f32_dpp v92, v100, v100 row_half_mirror row_mask:0xf bank_mask:0xa
    v_add_f32_dpp v93, v101, v101 row_half_mirror row_mask:0xf bank_mask:0xa
    v_add_f32_dpp v94, v102, v102 row_half_mirror row_mask:0xf bank_mask:0xa
    v_add_f32_dpp v95, v103, v103 row_half_mirror row_mask:0xf bank_mask:0xa
    v_add_f32_dpp v88, v88, v88 quad_perm:[1,0,3,2] row_mask:0xf bank_mask:0xf
    v_add_f32_dpp v89, v89, v89 quad_perm:[1,0,3,2] row_mask:0xf bank_mask:0xf
    v_add_f32_dpp v90, v90, v90 quad_perm:[1,0,3,2] row_mask:0xf bank_mask:0xf
    v_add_f32_dpp v91, v91, v91 quad_perm:[1,0,3,2] row_mask:0xf bank_mask:0xf
    v_add_f32_dpp v92, v92, v92 quad_perm:[1,0,3,2] row_mask:0xf bank_mask:0xf
    v_add_f32_dpp v93, v93, v93 quad_perm:[1,0,3,2] row_mask:0xf bank_mask:0xf
    v_add_f32_dpp v94, v94, v94 quad_perm:[1,0,3,2] row_mask:0xf bank_mask:0xf
    v_add_f32_dpp v95, v95, v95 quad_perm:[1,0,3,2] row_mask:0xf bank_mask:0xf
    v_add_f32_dpp v88, v88, v88 quad_perm:[2,3,0,1] row_mask:0xf bank_mask:0xf
    v_add_f32_dpp v89, v89, v89 quad_perm:[2,3,0,1] row_mask:0xf bank_mask:0xf
    v_add_f32_dpp v90, v90, v90 quad_perm:[2,3,0,1] row_mask:0xf bank_mask:0xf
    v_add_f32_dpp v91, v91, v91 quad_perm:[2,3,0,1] row_mask:0xf bank_mask:0xf
    v_add_f32_dpp v92, v92, v92 quad_perm:[2,3,0,1] row_mask:0xf bank_mask:0xf
    v_add_f32_dpp v93, v93, v93 quad_perm:[2,3,0,1] row_mask:0xf bank_mask:0xf
    v_add_f32_dpp v94, v94, v94 quad_perm:[2,3,0,1] row_mask:0xf bank_mask:0xf
    v_add_f32_dpp v95, v95, v95 quad_perm:[2,3,0,1] row_mask:0xf bank_mask:0xf
    v_cvt_pk_bf16_f32 v88, 0, v88
    v_cvt_pk_bf16_f32 v89, 0, v89
    v_cvt_pk_bf16_f32 v90, 0, v90
    v_cvt_pk_bf16_f32 v91, 0, v91
    v_cvt_pk_bf16_f32 v92, 0, v92
    v_cvt_pk_bf16_f32 v93, 0, v93
    v_cvt_pk_bf16_f32 v94, 0, v94
    v_cvt_pk_bf16_f32 v95, 0, v95
    v_mul_f32 v88, 0x3db504f3, v88
    v_mul_f32 v89, 0x3db504f3, v89
    v_mul_f32 v90, 0x3db504f3, v90
    v_mul_f32 v91, 0x3db504f3, v91
    v_mul_f32 v92, 0x3db504f3, v92
    v_mul_f32 v93, 0x3db504f3, v93
    v_mul_f32 v94, 0x3db504f3, v94
    v_mul_f32 v95, 0x3db504f3, v95
    v_cvt_pk_bf16_f32 v88, 0, v88
    v_cvt_pk_bf16_f32 v89, 0, v89
    v_cvt_pk_bf16_f32 v90, 0, v90
    v_cvt_pk_bf16_f32 v91, 0, v91
    v_cvt_pk_bf16_f32 v92, 0, v92
    v_cvt_pk_bf16_f32 v93, 0, v93
    v_cvt_pk_bf16_f32 v94, 0, v94
    v_cvt_pk_bf16_f32 v95, 0, v95
    v_max3_f32 v12, v88, v89, v90
    v_max3_f32 v13, v91, v92, v93
    v_max3_f32 v12, v12, v94, v95
    v_max_f32 v12, v12, v13

    s_nop 1
    v_max_f32_dpp v12, v12, v12 row_half_mirror row_mask:0xf bank_mask:0xf
    v_mov_b32 v13, v12
    s_nop 1
    v_permlane32_swap_b32 v12, v13
    v_max_f32 v12, v12, v13
    v_mov_b32 v13, v12
    s_nop 1
    v_permlane16_swap_b32 v12, v13
    v_max_f32 v12, v12, v13

    v_sub_f32 v88, v88, v12
    v_sub_f32 v89, v89, v12
    v_sub_f32 v90, v90, v12
    v_sub_f32 v91, v91, v12
    v_sub_f32 v92, v92, v12
    v_sub_f32 v93, v93, v12
    v_sub_f32 v94, v94, v12
    v_sub_f32 v95, v95, v12
    v_mul_f32 v88, 0x3fb8aa3b, v88
    v_mul_f32 v89, 0x3fb8aa3b, v89
    v_mul_f32 v90, 0x3fb8aa3b, v90
    v_mul_f32 v91, 0x3fb8aa3b, v91
    v_mul_f32 v92, 0x3fb8aa3b, v92
    v_mul_f32 v93, 0x3fb8aa3b, v93
    v_mul_f32 v94, 0x3fb8aa3b, v94
    v_mul_f32 v95, 0x3fb8aa3b, v95
    v_exp_f32 v88, v88
    v_exp_f32 v89, v89
    v_exp_f32 v90, v90
    v_exp_f32 v91, v91
    v_exp_f32 v92, v92
    v_exp_f32 v93, v93
    v_exp_f32 v94, v94
    v_exp_f32 v95, v95
    v_add_f32 v13, v88, v89
    v_add_f32 v3, v90, v91
    v_add_f32 v4, v92, v93
    v_add_f32 v5, v94, v95
    v_add_f32 v13, v13, v3
    v_add_f32 v4, v4, v5
    v_add_f32 v13, v13, v4

    v_cvt_pk_bf16_f32 v88, v88, v88
    v_cvt_pk_bf16_f32 v89, v89, v89
    v_cvt_pk_bf16_f32 v90, v90, v90
    v_cvt_pk_bf16_f32 v91, v91, v91
    v_cvt_pk_bf16_f32 v92, v92, v92
    v_cvt_pk_bf16_f32 v93, v93, v93
    v_cvt_pk_bf16_f32 v94, v94, v94
    v_cvt_pk_bf16_f32 v95, v95, v95
    v_add_f32_dpp v13, v13, v13 row_half_mirror row_mask:0xf bank_mask:0xf
    v_mov_b32 v3, v13
    s_nop 1
    v_permlane32_swap_b32 v13, v3
    v_add_f32 v13, v13, v3
    v_mov_b32 v3, v13
    s_nop 1
    v_permlane16_swap_b32 v13, v3
    v_add_f32 v13, v13, v3

    s_mov_b64 exec, s[62:63]
    ds_write_b128 v14, v[88:91] offset:6144
    ds_write_b128 v14, v[92:95] offset:6160
    ds_write_b64 v15, v[12:13] offset:128
    ds_write_b32 v10, v11 offset:80

    s_endpgm
L_Vbody:
    s_xor_b32 s57, s56, 4096
    s_xor_b32 s58, s56, 8192
    s_xor_b32 s59, s56, 12288
    s_lshl_b32 s61, s60, 2
    v_mov_b32 v10, s61
    v_mov_b32 v11, 1
    v_mov_b32 v6, 0
    v_lshrrev_b32 v14, 3, v1
    s_lshl_b32 s61, s60, 9
    v_lshl_add_u32 v14, v14, 6, s61
    s_lshl_b32 s61, s60, 10
    v_add_u32 v15, s61, v2

    v_and_b32 v3, 1, v1
    v_mov_b32 v4, 0xffff
    v_lshlrev_b32 v3, 4, v3
    v_lshlrev_b32 v4, v3, v4
    v_bfe_u32 v5, v1, 1, 2

    v_cmp_eq_u32 vcc, 0, v5
    s_nop 1
    v_cndmask_b32 v112, 0, v4, vcc
    v_cmp_eq_u32 vcc, 1, v5
    s_nop 1
    v_cndmask_b32 v113, 0, v4, vcc
    v_cmp_eq_u32 vcc, 2, v5
    s_nop 1
    v_cndmask_b32 v114, 0, v4, vcc
    v_cmp_eq_u32 vcc, 3, v5
    s_nop 1
    v_cndmask_b32 v115, 0, v4, vcc
    s_barrier
    s_movk_i32 s34, 16384
L_w_5:
    ds_read_b32 v8, v10 offset:64
    s_waitcnt lgkmcnt(0)
    v_cmp_ne_u32 vcc, 1, v8
    s_sub_u32 s34, s34, 1
    s_cbranch_scc1 L_d_6
    s_cbranch_vccnz L_w_5
L_d_6:

    s_setprio 2
    buffer_load_dwordx4 v[20:23], v2, s[36:39], s56 offen offset:1024 nt
    buffer_load_dwordx4 v[24:27], v2, s[36:39], s56 offen offset:2048 nt
    buffer_load_dwordx4 v[28:31], v2, s[36:39], s56 offen offset:3072 nt
    buffer_load_dwordx4 v[32:35], v2, s[36:39], s57 offen offset:0 nt
    s_mov_b64 exec, 1
    ds_add_u32 v6, v11 offset:124
    s_mov_b64 exec, -1
    s_waitcnt vmcnt(3)
    buffer_load_dwordx4 v[36:39], v2, s[36:39], s57 offen offset:1024 nt
    s_waitcnt vmcnt(3)
    buffer_load_dwordx4 v[40:43], v2, s[36:39], s57 offen offset:2048 nt
    s_waitcnt vmcnt(3)
    buffer_load_dwordx4 v[44:47], v2, s[36:39], s57 offen offset:3072 nt
    s_waitcnt vmcnt(3)
    buffer_load_dwordx4 v[48:51], v2, s[36:39], s58 offen offset:0 nt
    s_waitcnt vmcnt(3)
    buffer_load_dwordx4 v[52:55], v2, s[36:39], s58 offen offset:1024 nt
    s_waitcnt vmcnt(3)
    buffer_load_dwordx4 v[56:59], v2, s[36:39], s58 offen offset:2048 nt
    s_waitcnt vmcnt(3)
    buffer_load_dwordx4 v[60:63], v2, s[36:39], s58 offen offset:3072 nt
    s_waitcnt vmcnt(3)
    buffer_load_dwordx4 v[64:67], v2, s[36:39], s59 offen offset:0 nt
    s_waitcnt vmcnt(3)
    buffer_load_dwordx4 v[68:71], v2, s[36:39], s59 offen offset:1024 nt
    s_waitcnt vmcnt(3)
    buffer_load_dwordx4 v[72:75], v2, s[36:39], s59 offen offset:2048 nt
    s_waitcnt vmcnt(3)
    buffer_load_dwordx4 v[76:79], v2, s[36:39], s59 offen offset:3072 nt
    s_mov_b64 exec, 1
    ds_add_u32 v6, v11 offset:112
    s_mov_b64 exec, -1
    s_movk_i32 s34, 16384
L_w_7:
    ds_read_b32 v8, v10 offset:80
    ds_read_b128 v[80:83], v14 offset:6144
    ds_read_b128 v[84:87], v14 offset:6160
    ds_read_b128 v[88:91], v14 offset:6176
    ds_read_b128 v[92:95], v14 offset:6192
    s_waitcnt lgkmcnt(0)
    v_cmp_ne_u32 vcc, 1, v8
    s_sub_u32 s34, s34, 1
    s_cbranch_scc1 L_d_8
    s_cbranch_vccnz L_w_7
L_d_8:

    v_and_b32 v96, v80, v112
    v_and_b32 v97, v80, v113
    v_and_b32 v98, v80, v114
    v_and_b32 v99, v80, v115
    v_and_b32 v100, v81, v112
    v_and_b32 v101, v81, v113
    v_and_b32 v102, v81, v114
    v_and_b32 v103, v81, v115
    v_mfma_f32_16x16x32_bf16 v[116:119], v[96:99], v[16:19], 0
    v_and_b32 v96, v82, v112
    v_and_b32 v97, v82, v113
    v_and_b32 v98, v82, v114
    v_and_b32 v99, v82, v115
    v_mfma_f32_16x16x32_bf16 v[116:119], v[100:103], v[20:23], v[116:119]
    v_and_b32 v100, v83, v112
    v_and_b32 v101, v83, v113
    v_and_b32 v102, v83, v114
    v_and_b32 v103, v83, v115
    v_mfma_f32_16x16x32_bf16 v[116:119], v[96:99], v[24:27], v[116:119]
    v_and_b32 v96, v84, v112
    v_and_b32 v97, v84, v113
    v_and_b32 v98, v84, v114
    v_and_b32 v99, v84, v115
    v_mfma_f32_16x16x32_bf16 v[116:119], v[100:103], v[28:31], v[116:119]
    v_and_b32 v100, v85, v112
    v_and_b32 v101, v85, v113
    v_and_b32 v102, v85, v114
    v_and_b32 v103, v85, v115
    v_mfma_f32_16x16x32_bf16 v[116:119], v[96:99], v[32:35], v[116:119]
    v_and_b32 v96, v86, v112
    v_and_b32 v97, v86, v113
    v_and_b32 v98, v86, v114
    v_and_b32 v99, v86, v115
    v_mfma_f32_16x16x32_bf16 v[116:119], v[100:103], v[36:39], v[116:119]
    v_and_b32 v100, v87, v112
    v_and_b32 v101, v87, v113
    v_and_b32 v102, v87, v114
    v_and_b32 v103, v87, v115
    v_mfma_f32_16x16x32_bf16 v[116:119], v[96:99], v[40:43], v[116:119]
    v_and_b32 v96, v88, v112
    v_and_b32 v97, v88, v113
    v_and_b32 v98, v88, v114
    v_and_b32 v99, v88, v115
    v_mfma_f32_16x16x32_bf16 v[116:119], v[100:103], v[44:47], v[116:119]
    v_and_b32 v100, v89, v112
    v_and_b32 v101, v89, v113
    v_and_b32 v102, v89, v114
    v_and_b32 v103, v89, v115
    v_mfma_f32_16x16x32_bf16 v[116:119], v[96:99], v[48:51], v[116:119]
    v_and_b32 v96, v90, v112
    v_and_b32 v97, v90, v113
    v_and_b32 v98, v90, v114
    v_and_b32 v99, v90, v115
    v_mfma_f32_16x16x32_bf16 v[116:119], v[100:103], v[52:55], v[116:119]
    v_and_b32 v100, v91, v112
    v_and_b32 v101, v91, v113
    v_and_b32 v102, v91, v114
    v_and_b32 v103, v91, v115
    v_mfma_f32_16x16x32_bf16 v[116:119], v[96:99], v[56:59], v[116:119]
    s_nop 0
    v_mfma_f32_16x16x32_bf16 v[116:119], v[100:103], v[60:63], v[116:119]
    v_and_b32 v16, v92, v112
    v_and_b32 v17, v92, v113
    v_and_b32 v18, v92, v114
    v_and_b32 v19, v92, v115
    v_and_b32 v20, v93, v112
    v_and_b32 v21, v93, v113
    v_and_b32 v22, v93, v114
    v_and_b32 v23, v93, v115
    v_and_b32 v24, v94, v112
    v_and_b32 v25, v94, v113
    v_and_b32 v26, v94, v114
    v_and_b32 v27, v94, v115
    v_and_b32 v28, v95, v112
    v_and_b32 v29, v95, v113
    v_and_b32 v30, v95, v114
    v_and_b32 v31, v95, v115
    s_setprio 3
    s_waitcnt vmcnt(3)
    v_mfma_f32_16x16x32_bf16 v[116:119], v[16:19], v[64:67], v[116:119]
    s_waitcnt vmcnt(2)
    v_mfma_f32_16x16x32_bf16 v[116:119], v[20:23], v[68:71], v[116:119]
    s_waitcnt vmcnt(1)
    v_mfma_f32_16x16x32_bf16 v[116:119], v[24:27], v[72:75], v[116:119]
    s_waitcnt vmcnt(0)
    v_mfma_f32_16x16x32_bf16 v[116:119], v[28:31], v[76:79], v[116:119]
    s_nop 7
    ds_write_b128 v15, v[116:119] offset:8192
    ds_write_b32 v10, v11 offset:96
    s_endpgm
L_Qbody:
    s_barrier
    s_mul_i32 s62, s60, 576
    s_add_u32 s62, s62, 1536
    v_lshl_add_u32 v7, v3, 6, s62
    v_lshl_add_u32 v8, v3, 3, s62
    v_and_b32 v11, 15, v1
    v_lshrrev_b32 v9, 4, v1
    v_lshlrev_b32 v11, 5, v11
    v_lshl_or_b32 v11, v9, 4, v11
    v_mov_b32 v10, 0xffffff00
    s_lshl_b32 s62, s63, 12
    s_lshl_b32 s63, s60, 10
    s_add_u32 s62, s62, s63
    s_lshl_b32 s63, s61, 8
    s_add_u32 s62, s62, s63
    s_add_u32 s62, s62, 65536
    s_mov_b64 s[40:41], s[32:33]
    s_mov_b32 s42, 0x10000000
    s_mov_b32 s64, 0x00ff00ff
    s_mov_b32 s65, 0

    v_and_b32 v4, 1, v1
    v_mov_b32 v5, 0xffff
    v_lshlrev_b32 v4, 4, v4
    v_lshlrev_b32 v5, v4, v5
    v_bfe_u32 v6, v1, 1, 2

    v_cmp_eq_u32 vcc, 0, v6
    s_nop 1
    v_cndmask_b32 v12, 0, v5, vcc
    v_cmp_eq_u32 vcc, 1, v6
    s_nop 1
    v_cndmask_b32 v13, 0, v5, vcc
    v_cmp_eq_u32 vcc, 2, v6
    s_nop 1
    v_cndmask_b32 v14, 0, v5, vcc
    v_cmp_eq_u32 vcc, 3, v6
    s_nop 1
    v_cndmask_b32 v15, 0, v5, vcc
    s_getreg_b32 s0, hwreg(HW_REG_XCC_ID, 0, 4)
    s_movk_i32 s1, 256
    s_lshl_b32 s0, s0, 1
    v_mov_b32 v125, 0x3ae38e39
    v_lshlrev_b32 v126, 5, v1
    v_lshlrev_b32 v127, 2, v1
    s_waitcnt vmcnt(18)

L_LN0:
    v_lshlrev_b32 v88, 16, v120
    v_and_b32 v89, 0xffff0000, v120
    v_lshlrev_b32 v90, 16, v121
    v_and_b32 v91, 0xffff0000, v121
    v_lshlrev_b32 v92, 16, v122
    v_and_b32 v93, 0xffff0000, v122
    v_lshlrev_b32 v94, 16, v123
    v_and_b32 v95, 0xffff0000, v123
    v_lshlrev_b32 v96, 16, v124
L_LN:
    v_add_f32 v107, v88, v89
    v_add_f32 v108, v90, v91
    v_add_f32 v109, v92, v93
    v_add_f32 v110, v94, v95
    v_add_f32 v107, v107, v96
    v_add_f32 v108, v108, v109
    v_add_f32 v107, v107, v110
    v_add_f32 v107, v107, v108

    s_nop 1
    v_add_f32_dpp v107, v107, v107 row_ror:8 row_mask:0xf bank_mask:0xf
    s_nop 1
    v_add_f32_dpp v107, v107, v107 row_ror:4 row_mask:0xf bank_mask:0xf
    s_nop 1
    v_add_f32_dpp v107, v107, v107 row_ror:2 row_mask:0xf bank_mask:0xf
    s_nop 1
    v_add_f32_dpp v107, v107, v107 row_ror:1 row_mask:0xf bank_mask:0xf
    s_nop 1
    v_add_f32_dpp v107, v107, v107 row_bcast:15 row_mask:0xa bank_mask:0xf
    s_nop 1
    v_add_f32_dpp v107, v107, v107 row_bcast:31 row_mask:0xc bank_mask:0xf
    s_nop 0
    v_readlane_b32 s66, v107, 63
    s_nop 1
    v_mul_f32 v108, s66, v125
    v_sub_f32 v109, v88, v108
    v_sub_f32 v110, v89, v108
    v_sub_f32 v111, v90, v108
    v_sub_f32 v112, v91, v108
    v_sub_f32 v113, v92, v108
    v_sub_f32 v114, v93, v108
    v_sub_f32 v115, v94, v108
    v_sub_f32 v116, v95, v108
    v_sub_f32 v117, v96, v108
    v_mul_f32 v107, v109, v109
    v_mul_f32 v118, v110, v110
    v_fmac_f32 v107, v111, v111
    v_fmac_f32 v118, v112, v112
    v_fmac_f32 v107, v113, v113
    v_fmac_f32 v118, v114, v114
    v_fmac_f32 v107, v115, v115
    v_fmac_f32 v118, v116, v116
    v_fmac_f32 v107, v117, v117
    v_add_f32 v107, v107, v118
    v_cvt_pk_bf16_f32 v108, 0, v108
    s_nop 0
    v_add_f32_dpp v107, v107, v107 row_ror:8 row_mask:0xf bank_mask:0xf
    v_sub_f32 v109, v88, v108
    v_sub_f32 v110, v89, v108
    v_add_f32_dpp v107, v107, v107 row_ror:4 row_mask:0xf bank_mask:0xf
    v_sub_f32 v111, v90, v108
    v_sub_f32 v112, v91, v108
    v_add_f32_dpp v107, v107, v107 row_ror:2 row_mask:0xf bank_mask:0xf
    v_sub_f32 v113, v92, v108
    v_sub_f32 v114, v93, v108
    v_add_f32_dpp v107, v107, v107 row_ror:1 row_mask:0xf bank_mask:0xf
    v_sub_f32 v115, v94, v108
    v_sub_f32 v116, v95, v108
    v_add_f32_dpp v107, v107, v107 row_bcast:15 row_mask:0xa bank_mask:0xf
    v_sub_f32 v117, v96, v108
    v_cvt_pk_bf16_f32 v109, 0, v109
    v_add_f32_dpp v107, v107, v107 row_bcast:31 row_mask:0xc bank_mask:0xf
    v_cvt_pk_bf16_f32 v110, 0, v110
    v_cvt_pk_bf16_f32 v111, 0, v111
    v_readlane_b32 s67, v107, 63
    v_cvt_pk_bf16_f32 v112, 0, v112
    v_cvt_pk_bf16_f32 v113, 0, v113
    v_mul_f32 v107, s67, v125
    v_cvt_pk_bf16_f32 v107, 0, v107
    v_add_f32 v107, 0x3727c5ac, v107
    v_cvt_pk_bf16_f32 v107, 0, v107
    v_sqrt_f32 v107, v107

    v_cvt_pk_bf16_f32 v114, 0, v114
    v_cvt_pk_bf16_f32 v115, 0, v115
    v_cvt_pk_bf16_f32 v107, 0, v107
    v_rcp_f32 v108, v107

    v_cvt_pk_bf16_f32 v116, 0, v116
    v_cvt_pk_bf16_f32 v117, 0, v117
    v_mul_f32 v98, v109, v108
    v_mul_f32 v99, v110, v108
    v_mul_f32 v100, v111, v108
    v_mul_f32 v101, v112, v108
    v_mul_f32 v102, v113, v108
    v_mul_f32 v103, v114, v108
    v_mul_f32 v104, v115, v108
    v_mul_f32 v105, v116, v108
    v_mul_f32 v106, v117, v108
    v_fma_f32 v109, -v98, v107, v109
    v_fma_f32 v110, -v99, v107, v110
    v_fma_f32 v111, -v100, v107, v111
    v_fma_f32 v112, -v101, v107, v112
    v_fma_f32 v113, -v102, v107, v113
    v_fma_f32 v114, -v103, v107, v114
    v_fma_f32 v115, -v104, v107, v115
    v_fma_f32 v116, -v105, v107, v116
    v_fma_f32 v117, -v106, v107, v117
    v_fmac_f32 v98, v109, v108
    v_fmac_f32 v99, v110, v108
    v_fmac_f32 v100, v111, v108
    v_fmac_f32 v101, v112, v108
    v_fmac_f32 v102, v113, v108
    v_fmac_f32 v103, v114, v108
    v_fmac_f32 v104, v115, v108
    v_fmac_f32 v105, v116, v108
    v_fmac_f32 v106, v117, v108
    v_cvt_pk_bf16_f32 v98, v98, v98
    v_cvt_pk_bf16_f32 v99, v99, v99
    v_cvt_pk_bf16_f32 v100, v100, v100
    v_cvt_pk_bf16_f32 v101, v101, v101
    v_cvt_pk_bf16_f32 v102, v102, v102
    v_cvt_pk_bf16_f32 v103, v103, v103
    v_cvt_pk_bf16_f32 v104, v104, v104
    v_cvt_pk_bf16_f32 v105, v105, v105
    v_cvt_pk_bf16_f32 v106, v106, v106
    s_cmp_eq_u32 s3, 5
    s_cbranch_scc1 L_S1
    ds_write_b128 v126, v[98:101] offset:1536
    ds_write_b128 v126, v[102:105] offset:1552
    ds_write_b32 v127, v106 offset:3584
    s_cmp_lg_u32 s3, 0
    s_cbranch_scc1 L_Sbody
    v_mov_b32 v107, 1
    ds_write_b32 v107, v107 offset:11

    ds_read_b128 v[88:91], v7 offset:0
    ds_read_b128 v[92:95], v7 offset:16
    ds_read_b128 v[96:99], v7 offset:32
    ds_read_b128 v[100:103], v7 offset:48
    ds_read_b64 v[104:105], v8 offset:512
    s_waitcnt lgkmcnt(0)
    v_and_b32 v106, v88, v12
    v_and_b32 v107, v88, v13
    v_and_b32 v108, v88, v14
    v_and_b32 v109, v88, v15
    v_and_b32 v110, v89, v12
    v_and_b32 v111, v89, v13
    v_and_b32 v112, v89, v14
    v_and_b32 v113, v89, v15
    s_waitcnt vmcnt(17)
    v_mfma_f32_16x16x32_bf16 v[116:119], v[106:109], v[16:19], 0
    v_and_b32 v106, v90, v12
    v_and_b32 v107, v90, v13
    v_and_b32 v108, v90, v14
    v_and_b32 v109, v90, v15
    s_waitcnt vmcnt(16)
    v_mfma_f32_16x16x32_bf16 v[116:119], v[110:113], v[20:23], v[116:119]
    v_and_b32 v110, v91, v12
    v_and_b32 v111, v91, v13
    v_and_b32 v112, v91, v14
    v_and_b32 v113, v91, v15
    s_waitcnt vmcnt(15)
    v_mfma_f32_16x16x32_bf16 v[116:119], v[106:109], v[24:27], v[116:119]
    v_and_b32 v106, v92, v12
    v_and_b32 v107, v92, v13
    v_and_b32 v108, v92, v14
    v_and_b32 v109, v92, v15
    s_waitcnt vmcnt(14)
    v_mfma_f32_16x16x32_bf16 v[116:119], v[110:113], v[28:31], v[116:119]
    v_and_b32 v110, v93, v12
    v_and_b32 v111, v93, v13
    v_and_b32 v112, v93, v14
    v_and_b32 v113, v93, v15
    s_waitcnt vmcnt(13)
    v_mfma_f32_16x16x32_bf16 v[116:119], v[106:109], v[32:35], v[116:119]
    v_and_b32 v106, v94, v12
    v_and_b32 v107, v94, v13
    v_and_b32 v108, v94, v14
    v_and_b32 v109, v94, v15
    s_waitcnt vmcnt(12)
    v_mfma_f32_16x16x32_bf16 v[116:119], v[110:113], v[36:39], v[116:119]
    v_and_b32 v110, v95, v12
    v_and_b32 v111, v95, v13
    v_and_b32 v112, v95, v14
    v_and_b32 v113, v95, v15
    s_waitcnt vmcnt(11)
    v_mfma_f32_16x16x32_bf16 v[116:119], v[106:109], v[40:43], v[116:119]
    v_and_b32 v106, v96, v12
    v_and_b32 v107, v96, v13
    v_and_b32 v108, v96, v14
    v_and_b32 v109, v96, v15
    s_waitcnt vmcnt(10)
    v_mfma_f32_16x16x32_bf16 v[116:119], v[110:113], v[44:47], v[116:119]
    v_and_b32 v110, v97, v12
    v_and_b32 v111, v97, v13
    v_and_b32 v112, v97, v14
    v_and_b32 v113, v97, v15
    s_waitcnt vmcnt(9)
    v_mfma_f32_16x16x32_bf16 v[116:119], v[106:109], v[48:51], v[116:119]
    v_and_b32 v106, v98, v12
    v_and_b32 v107, v98, v13
    v_and_b32 v108, v98, v14
    v_and_b32 v109, v98, v15
    s_waitcnt vmcnt(8)
    v_mfma_f32_16x16x32_bf16 v[116:119], v[110:113], v[52:55], v[116:119]
    v_and_b32 v110, v99, v12
    v_and_b32 v111, v99, v13
    v_and_b32 v112, v99, v14
    v_and_b32 v113, v99, v15
    s_waitcnt vmcnt(7)
    v_mfma_f32_16x16x32_bf16 v[116:119], v[106:109], v[56:59], v[116:119]
    v_and_b32 v106, v100, v12
    v_and_b32 v107, v100, v13
    v_and_b32 v108, v100, v14
    v_and_b32 v109, v100, v15
    s_waitcnt vmcnt(6)
    v_mfma_f32_16x16x32_bf16 v[116:119], v[110:113], v[60:63], v[116:119]
    v_and_b32 v110, v101, v12
    v_and_b32 v111, v101, v13
    v_and_b32 v112, v101, v14
    v_and_b32 v113, v101, v15
    s_waitcnt vmcnt(5)
    v_mfma_f32_16x16x32_bf16 v[116:119], v[106:109], v[64:67], v[116:119]
    v_and_b32 v106, v102, v12
    v_and_b32 v107, v102, v13
    v_and_b32 v108, v102, v14
    v_and_b32 v109, v102, v15
    s_waitcnt vmcnt(4)
    v_mfma_f32_16x16x32_bf16 v[116:119], v[110:113], v[68:71], v[116:119]
    v_and_b32 v110, v103, v12
    v_and_b32 v111, v103, v13
    v_and_b32 v112, v103, v14
    v_and_b32 v113, v103, v15
    s_waitcnt vmcnt(3)
    v_mfma_f32_16x16x32_bf16 v[116:119], v[106:109], v[72:75], v[116:119]
    v_and_b32 v106, v104, v12
    v_and_b32 v107, v104, v13
    v_and_b32 v108, v104, v14
    v_and_b32 v109, v104, v15
    s_waitcnt vmcnt(2)
    v_mfma_f32_16x16x32_bf16 v[116:119], v[110:113], v[76:79], v[116:119]
    v_and_b32 v110, v105, v12
    v_and_b32 v111, v105, v13
    v_and_b32 v112, v105, v14
    v_and_b32 v113, v105, v15
    s_waitcnt vmcnt(1)
    v_mfma_f32_16x16x32_bf16 v[116:119], v[106:109], v[80:83], v[116:119]
    s_waitcnt vmcnt(0)
    v_mfma_f32_16x16x32_bf16 v[116:119], v[110:113], v[84:87], v[116:119]
    s_mul_i32 s72, s73, 1664525
    s_add_u32 s72, s72, 1013904223
    s_or_b32 s72, s72, 0x01010101
    s_xor_b32 s72, s72, s73
    s_nop 3
    v_mov_b32 v106, v116
    v_mov_b32 v107, v117
    v_mov_b32 v108, v118
    v_mov_b32 v109, v119
    s_and_b32 s68, s72, 0xff
    s_xor_b32 s68, s68, s0
    v_permlane32_swap_b32 v116, v106
    v_permlane32_swap_b32 v117, v107
    v_permlane32_swap_b32 v118, v108
    v_permlane32_swap_b32 v119, v109
    s_bfe_u32 s69, s72, 0x80008
    v_add_f32_dpp v116, v106, v116 row_ror:8 row_mask:0xf bank_mask:0xf
    v_add_f32_dpp v117, v107, v117 row_ror:8 row_mask:0xf bank_mask:0xf
    v_add_f32_dpp v118, v108, v118 row_ror:8 row_mask:0xf bank_mask:0xf
    v_add_f32_dpp v119, v109, v119 row_ror:8 row_mask:0xf bank_mask:0xf
    s_bfe_u32 s70, s72, 0x80010
    s_lshr_b32 s71, s72, 24
    v_add_u32 v116, 0x80, v116
    v_add_u32 v117, 0x80, v117
    v_add_u32 v118, 0x80, v118
    v_add_u32 v119, 0x80, v119
    v_and_or_b32 v116, v116, v10, s68
    v_and_or_b32 v117, v117, v10, s69
    v_and_or_b32 v118, v118, v10, s70
    v_and_or_b32 v119, v119, v10, s71
    s_mov_b64 exec, s[64:65]
    buffer_store_dwordx4 v[116:119], v11, s[40:43], s62 offen
    s_mov_b64 exec, -1

    s_setprio 0
    v_and_b32 v3, 15, v1
    v_lshrrev_b32 v4, 4, v1
    v_lshlrev_b32 v10, 6, v3
    v_lshlrev_b32 v10, 4, v1
    v_lshlrev_b32 v11, 4, v3
    v_bfe_u32 v3, v1, 3, 1
    v_lshlrev_b32 v4, 4, v4
    v_lshl_or_b32 v12, v3, 2, v4
    v_mov_b32 v60, 0
    v_mov_b32 v61, 1
    s_lshl_b32 s56, s4, 4
    s_add_u32 s56, s56, s5
    s_lshl_b32 s56, s56, 11
    s_add_u32 s56, s56, 131072
    s_mov_b64 s[8:9], -1
    v_not_b32 v16, s68

    v_mov_b32 v63, -1
    s_waitcnt vmcnt(0)
    ds_write_b32 v60, v61 offset:52
    v_not_b32 v64, s68
    v_not_b32 v68, s68
    v_not_b32 v72, s68
    v_not_b32 v76, s68
    s_mov_b64 s[10:11], -1
    s_movk_i32 s34, 16384
L_w_9:
    ds_read_b32 v8, v60 offset:40
    s_waitcnt lgkmcnt(0)
    v_cmp_ne_u32 vcc, 1, v8
    s_sub_u32 s34, s34, 1
    s_cbranch_scc1 L_d_10
    s_cbranch_vccnz L_w_9
L_d_10:

    s_setprio 3
    s_mov_b32 s34, 32
L_g0_13:
    s_waitcnt vmcnt(3)
    s_mov_b64 exec, s[8:9]
    v_bitop3_b32 v20, s68, v64, v63 bitop3:0x28
    v_xor_b32 v21, s69, v65
    v_xor_b32 v22, s70, v66
    v_xor_b32 v23, s71, v67
    v_or3_b32 v5, v20, v21, v22
    v_or_b32 v5, v5, v23
    v_cmp_ne_u32_sdwa s[8:9], v5, 0 src0_sel:BYTE_0 src1_sel:DWORD

    s_or_b64 exec, s[8:9], 1
    buffer_load_dwordx4 v[64:67], v11, s[40:43], s56 offen offset:1024 sc1
    s_waitcnt vmcnt(3)
    s_mov_b64 exec, s[10:11]
    v_bitop3_b32 v24, s68, v68, v63 bitop3:0x28
    v_xor_b32 v25, s69, v69
    v_xor_b32 v26, s70, v70
    v_xor_b32 v27, s71, v71
    v_or3_b32 v5, v24, v25, v26
    v_or_b32 v5, v5, v27
    v_cmp_ne_u32_sdwa s[10:11], v5, 0 src0_sel:BYTE_0 src1_sel:DWORD

    s_or_b64 exec, s[10:11], 1
    buffer_load_dwordx4 v[68:71], v10, s[40:43], s56 offen sc1
    s_or_b64 s[16:17], s[8:9], s[10:11]
    s_cbranch_scc0 L_od_11
    s_sub_u32 s34, s34, 1
    s_cbranch_scc1 L_fb_14
    s_waitcnt vmcnt(3)
    s_mov_b64 exec, s[8:9]
    v_bitop3_b32 v20, s68, v72, v63 bitop3:0x28
    v_xor_b32 v21, s69, v73
    v_xor_b32 v22, s70, v74
    v_xor_b32 v23, s71, v75
    v_or3_b32 v5, v20, v21, v22
    v_or_b32 v5, v5, v23
    v_cmp_ne_u32_sdwa s[8:9], v5, 0 src0_sel:BYTE_0 src1_sel:DWORD

    s_or_b64 exec, s[8:9], 1
    buffer_load_dwordx4 v[72:75], v11, s[40:43], s56 offen offset:1024 sc1
    s_waitcnt vmcnt(3)
    s_mov_b64 exec, s[10:11]
    v_bitop3_b32 v24, s68, v76, v63 bitop3:0x28
    v_xor_b32 v25, s69, v77
    v_xor_b32 v26, s70, v78
    v_xor_b32 v27, s71, v79
    v_or3_b32 v5, v24, v25, v26
    v_or_b32 v5, v5, v27
    v_cmp_ne_u32_sdwa s[10:11], v5, 0 src0_sel:BYTE_0 src1_sel:DWORD

    s_or_b64 exec, s[10:11], 1
    buffer_load_dwordx4 v[76:79], v10, s[40:43], s56 offen sc1
    s_or_b64 s[16:17], s[8:9], s[10:11]
    s_cbranch_scc0 L_od_11
    s_branch L_g0_13
L_fb_14:
    s_mov_b64 exec, -1
    s_sub_u32 s1, s1, 1
    s_cbranch_scc1 L_od_11
    s_waitcnt vmcnt(0)
    s_movk_i32 s34, 16384
L_w_15:
    ds_read_b32 v8, v60 offset:56
    s_waitcnt lgkmcnt(0)
    v_cmp_ne_u32 vcc, 1, v8
    s_sub_u32 s34, s34, 1
    s_cbranch_scc1 L_d_16
    s_cbranch_vccnz L_w_15
L_d_16:

    buffer_wbl2 sc1
    s_waitcnt vmcnt(0)
    buffer_inv sc1
    s_waitcnt vmcnt(0)
    v_mov_b32 v63, 0xffffffe1
    s_mov_b32 s34, 1
    s_branch L_g0_13

L_od_11:
    s_mov_b64 exec, -1
    v_max_f32_dpp v22, v20, v20 row_ror:8 row_mask:0xf bank_mask:0xf
    s_nop 1
    v_max_f32_dpp v22, v22, v22 row_ror:4 row_mask:0xf bank_mask:0xf
    s_nop 1
    v_max_f32_dpp v22, v22, v22 row_ror:2 row_mask:0xf bank_mask:0xf
    s_nop 1
    v_max_f32_dpp v22, v22, v22 row_ror:1 row_mask:0xf bank_mask:0xf
    v_sub_f32 v20, v20, v22
    v_mul_f32 v20, 0x3fb8aa3b, v20
    v_exp_f32 v20, v20
    s_nop 0
    v_mul_f32 v21, v21, v20

    s_nop 1
    v_add_f32_dpp v21, v21, v21 row_ror:8 row_mask:0xf bank_mask:0xf
    s_nop 1
    v_add_f32_dpp v21, v21, v21 row_ror:4 row_mask:0xf bank_mask:0xf
    s_nop 1
    v_add_f32_dpp v21, v21, v21 row_ror:2 row_mask:0xf bank_mask:0xf
    s_nop 1
    v_add_f32_dpp v21, v21, v21 row_ror:1 row_mask:0xf bank_mask:0xf
    v_rcp_f32 v21, v21
    v_mul_f32 v24, v24, v20
    v_mul_f32 v26, v26, v20
    v_mul_f32 v25, v25, v20
    v_mul_f32 v27, v27, v20
    v_add_f32_dpp v24, v24, v24 row_ror:8 row_mask:0xf bank_mask:0x3
    v_add_f32_dpp v26, v26, v26 row_ror:8 row_mask:0xf bank_mask:0x3
    s_nop 0
    v_add_f32_dpp v24, v25, v25 row_ror:8 row_mask:0xf bank_mask:0xc
    v_add_f32_dpp v26, v27, v27 row_ror:8 row_mask:0xf bank_mask:0xc

    s_nop 0
    v_add_f32_dpp v24, v24, v24 row_half_mirror row_mask:0xf bank_mask:0xf
    v_add_f32_dpp v26, v26, v26 row_half_mirror row_mask:0xf bank_mask:0xf
    s_nop 0
    v_add_f32_dpp v24, v24, v24 quad_perm:[1,0,3,2] row_mask:0xf bank_mask:0xf
    v_add_f32_dpp v26, v26, v26 quad_perm:[1,0,3,2] row_mask:0xf bank_mask:0xf
    s_nop 0
    v_add_f32_dpp v24, v24, v24 quad_perm:[2,3,0,1] row_mask:0xf bank_mask:0xf
    v_add_f32_dpp v26, v26, v26 quad_perm:[2,3,0,1] row_mask:0xf bank_mask:0xf
    v_mul_f32 v24, v24, v21
    v_mul_f32 v26, v26, v21
    v_cvt_pk_bf16_f32 v24, v24, v24
    v_cvt_pk_bf16_f32 v26, v26, v26
    ds_write2_b32 v12, v24, v26 offset0:128 offset1:130
    ds_write_b32 v60, v61 offset:20

    s_endpgm
L_S1:
    v_and_b32 v88, 0xffff0000, v98
    v_and_b32 v89, 0xffff0000, v99
    v_and_b32 v90, 0xffff0000, v100
    v_and_b32 v91, 0xffff0000, v101
    v_and_b32 v92, 0xffff0000, v102
    v_and_b32 v93, 0xffff0000, v103
    v_and_b32 v94, 0xffff0000, v104
    v_and_b32 v95, 0xffff0000, v105
    v_and_b32 v96, 0xffff0000, v106
    v_add_u32 v126, 2304, v126
    v_add_u32 v127, 2304, v127
    s_mov_b32 s3, 2
    s_branch L_LN

L_Sbody:
    v_mov_b32 v60, 0
    v_mov_b32 v61, 1
    ds_write_b32 v60, v61 offset:4
    s_setprio 0
    v_and_b32 v16, 3, v1
    v_lshlrev_b32 v16, 2, v16
    v_lshlrev_b32 v62, 3, v1
    s_lshl_b32 s62, s4, 12
    s_add_u32 s62, s62, 65536
    v_mov_b32 v59, 0xffffff00
    v_lshrrev_b32 v3, 5, v1
    v_lshlrev_b32 v19, 5, v3
    v_and_b32 v4, 7, v1
    v_lshl_or_b32 v4, v3, 3, v4
    v_lshlrev_b32 v18, 11, v4
    v_bfe_u32 v4, v1, 1, 3
    v_lshl_or_b32 v3, v3, 3, v4
    v_lshlrev_b32 v17, 11, v3
    v_and_b32 v3, 1, v1
    v_lshl_or_b32 v17, v3, 9, v17
    v_bfe_u32 v3, v1, 4, 1
    v_lshl_or_b32 v17, v3, 8, v17
    s_lshl_b32 s56, s4, 15
    s_add_u32 s56, s56, 131072
    s_lshl_b32 s57, s5, 4
    s_add_u32 s57, s57, s56
    s_lshl_b32 s66, s5, 4
    s_add_u32 s66, s66, s56
    s_movk_i32 s64, 0xff
    s_movk_i32 s65, 0xff
    s_mov_b64 s[8:9], -1
    s_mov_b64 s[10:11], -1
    s_mov_b64 s[12:13], -1
    s_mov_b64 s[14:15], -1
    s_waitcnt lgkmcnt(0)

    s_getreg_b32 s0, hwreg(HW_REG_XCC_ID, 0, 4)
    s_movk_i32 s1, 256
    s_lshl_b32 s0, s0, 1
    v_mov_b32 v63, -1
    s_mul_i32 s72, s73, 1664525
    s_add_u32 s72, s72, 1013904223
    s_or_b32 s72, s72, 0x01010101
    s_xor_b32 s72, s72, s73
    s_and_b32 s68, s72, 0xff
    s_xor_b32 s68, s68, s0
    s_bfe_u32 s69, s72, 0x80008
    s_bfe_u32 s70, s72, 0x80010
    s_lshr_b32 s71, s72, 24
    v_not_b32 v112, s68
    v_not_b32 v116, s68
    v_not_b32 v120, s68
    v_not_b32 v124, s68
    s_movk_i32 s34, 16384
L_w_17:
    ds_read_b32 v8, v60 offset:124
    s_waitcnt lgkmcnt(0)
    v_cmp_gt_u32 vcc, 4, v8
    s_sub_u32 s34, s34, 1
    s_cbranch_scc1 L_d_18
    s_cbranch_vccnz L_w_17
L_d_18:

    s_mov_b32 s34, 32
L_gs_20:
    s_waitcnt vmcnt(0)
L_g0_21:
    s_mov_b64 exec, s[8:9]
    v_bitop3_b32 v96, s68, v112, v63 bitop3:0x28
    v_xor_b32 v97, s69, v113
    v_xor_b32 v98, s70, v114
    v_xor_b32 v99, s71, v115
    v_or3_b32 v5, v96, v97, v98
    v_or_b32 v5, v5, v99
    v_cmp_ne_u32_sdwa s[8:9], v5, 0 src0_sel:BYTE_0 src1_sel:DWORD

    s_or_b64 exec, s[8:9], 1
    buffer_load_dwordx4 v[112:115], v2, s[40:43], s62 offen offset:0 sc1
    s_mov_b64 exec, s[10:11]
    v_bitop3_b32 v100, s68, v116, v63 bitop3:0x28
    v_xor_b32 v101, s69, v117
    v_xor_b32 v102, s70, v118
    v_xor_b32 v103, s71, v119
    v_or3_b32 v5, v100, v101, v102
    v_or_b32 v5, v5, v103
    v_cmp_ne_u32_sdwa s[10:11], v5, 0 src0_sel:BYTE_0 src1_sel:DWORD

    s_or_b64 exec, s[10:11], 1
    buffer_load_dwordx4 v[116:119], v2, s[40:43], s62 offen offset:1024 sc1
    s_mov_b64 exec, s[12:13]
    v_bitop3_b32 v104, s68, v120, v63 bitop3:0x28
    v_xor_b32 v105, s69, v121
    v_xor_b32 v106, s70, v122
    v_xor_b32 v107, s71, v123
    v_or3_b32 v5, v104, v105, v106
    v_or_b32 v5, v5, v107
    v_cmp_ne_u32_sdwa s[12:13], v5, 0 src0_sel:BYTE_0 src1_sel:DWORD

    s_or_b64 exec, s[12:13], 1
    buffer_load_dwordx4 v[120:123], v2, s[40:43], s62 offen offset:2048 sc1
    s_mov_b64 exec, s[14:15]
    v_bitop3_b32 v108, s68, v124, v63 bitop3:0x28
    v_xor_b32 v109, s69, v125
    v_xor_b32 v110, s70, v126
    v_xor_b32 v111, s71, v127
    v_or3_b32 v5, v108, v109, v110
    v_or_b32 v5, v5, v111
    v_cmp_ne_u32_sdwa s[14:15], v5, 0 src0_sel:BYTE_0 src1_sel:DWORD

    s_or_b64 exec, s[14:15], 1
    buffer_load_dwordx4 v[124:127], v2, s[40:43], s62 offen offset:3072 sc1
    s_or_b64 s[16:17], s[8:9], s[10:11]
    s_or_b64 s[18:19], s[12:13], s[14:15]
    s_or_b64 s[16:17], s[16:17], s[18:19]
    s_cbranch_scc0 L_qd_19

    s_sub_u32 s34, s34, 1
    s_cbranch_scc1 L_fb_22
    s_branch L_gs_20
L_fb_22:
    s_mov_b64 exec, -1
    s_sub_u32 s1, s1, 1
    s_cbranch_scc1 L_qd_19
    s_waitcnt vmcnt(0)
    s_movk_i32 s34, 16384
L_w_23:
    ds_read_b32 v8, v60 offset:52
    s_waitcnt lgkmcnt(0)
    v_cmp_ne_u32 vcc, 1, v8
    s_sub_u32 s34, s34, 1
    s_cbranch_scc1 L_d_24
    s_cbranch_vccnz L_w_23
L_d_24:

    buffer_wbl2 sc1
    s_waitcnt vmcnt(0)
    buffer_inv sc1
    s_waitcnt vmcnt(0)
    v_mov_b32 v63, 0xffffffe1
    s_mov_b32 s34, 1
    s_branch L_g0_21

L_qd_19:
    s_mov_b64 exec, -1
    v_pk_add_f32 v[96:97], v[96:97], v[100:101]
    v_pk_add_f32 v[98:99], v[98:99], v[102:103]
    v_pk_add_f32 v[104:105], v[104:105], v[108:109]
    v_pk_add_f32 v[106:107], v[106:107], v[110:111]
    v_pk_add_f32 v[96:97], v[96:97], v[104:105]
    v_pk_add_f32 v[98:99], v[98:99], v[106:107]
    v_cvt_pk_bf16_f32 v4, v96, v97
    v_cvt_pk_bf16_f32 v5, v98, v99
    ds_write_b64 v62, v[4:5] offset:1024
    ds_write_b32 v60, v61 offset:8

    s_movk_i32 s34, 16384
L_w_25:
    ds_read_b32 v8, v16 offset:80
    ds_read_b128 v[20:23], v19 offset:128
    ds_read_b128 v[24:27], v19 offset:144
    s_waitcnt lgkmcnt(0)
    v_cmp_ne_u32 vcc, 1, v8
    s_sub_u32 s34, s34, 1
    s_cbranch_scc1 L_d_26
    s_cbranch_vccnz L_w_25
L_d_26:

    v_max3_f32 v4, v20, v22, v24
    v_max_f32 v4, v4, v26

    v_sub_f32 v28, v20, v4
    v_sub_f32 v29, v22, v4
    v_sub_f32 v30, v24, v4
    v_sub_f32 v31, v26, v4
    v_mul_f32 v28, 0x3fb8aa3b, v28
    v_mul_f32 v29, 0x3fb8aa3b, v29
    v_mul_f32 v30, 0x3fb8aa3b, v30
    v_mul_f32 v31, 0x3fb8aa3b, v31
    v_exp_f32 v28, v28
    v_exp_f32 v29, v29
    v_exp_f32 v30, v30
    v_exp_f32 v31, v31
    v_mul_f32 v5, v21, v28
    v_fmac_f32 v5, v23, v29
    v_fmac_f32 v5, v25, v30
    v_fmac_f32 v5, v27, v31
    v_and_or_b32 v6, v4, v59, s70
    v_and_or_b32 v4, v4, v59, s68
    v_and_or_b32 v7, v5, v59, s71
    v_and_or_b32 v5, v5, v59, s69
    s_mov_b64 exec, s[64:65]
    buffer_store_dwordx4 v[4:7], v18, s[40:43], s66 offen offset:1024
    s_mov_b64 exec, -1
    ds_write_b32 v60, v61 offset:36
    s_setprio 3

    s_movk_i32 s34, 16384
L_w_27:
    ds_read_b32 v8, v16 offset:96
    ds_read_b128 v[32:35], v2 offset:8192
    ds_read_b128 v[36:39], v2 offset:9216
    ds_read_b128 v[40:43], v2 offset:10240
    ds_read_b128 v[44:47], v2 offset:11264
    s_waitcnt lgkmcnt(0)
    v_cmp_ne_u32 vcc, 1, v8
    s_sub_u32 s34, s34, 1
    s_cbranch_scc1 L_d_28
    s_cbranch_vccnz L_w_27
L_d_28:

    v_mul_f32 v32, v32, v28
    v_mul_f32 v33, v33, v28
    v_mul_f32 v34, v34, v28
    v_mul_f32 v35, v35, v28
    v_fmac_f32 v32, v36, v29
    v_fmac_f32 v33, v37, v29
    v_fmac_f32 v34, v38, v29
    v_fmac_f32 v35, v39, v29
    v_fmac_f32 v32, v40, v30
    v_fmac_f32 v33, v41, v30
    v_fmac_f32 v34, v42, v30
    v_fmac_f32 v35, v43, v30
    v_fmac_f32 v32, v44, v31
    v_fmac_f32 v33, v45, v31
    v_fmac_f32 v34, v46, v31
    v_fmac_f32 v35, v47, v31
    v_and_or_b32 v32, v32, v59, s68
    v_and_or_b32 v33, v33, v59, s69
    v_and_or_b32 v34, v34, v59, s70
    v_and_or_b32 v35, v35, v59, s71
    buffer_store_dwordx4 v[32:35], v17, s[40:43], s57 offen
    ds_write_b32 v60, v61 offset:40
    s_waitcnt vmcnt(0)
    ds_write_b32 v60, v61 offset:56
    s_endpgm
L_Wbody:
    s_barrier
    s_mul_i32 s61, s7, 72
    s_add_u32 s61, s61, 3840
    v_lshl_add_u32 v6, v3, 3, s61
    v_lshl_add_u32 v7, v14, 2, s61
    v_add_u32 v7, 64, v7
    v_lshlrev_b32 v11, 1, v4
    v_lshl_or_b32 v11, v14, 4, v11
    v_lshl_or_b32 v11, v12, 8, v11
    v_lshl_or_b32 v11, v13, 9, v11
    v_cmp_gt_u32 vcc, 0x300, v11
    v_mov_b32 v8, 0
    v_mov_b32 v10, 1
    v_cndmask_b32 v11, v15, v11, vcc
    v_cmp_eq_u32 vcc, v12, v13
    v_mov_b32 v2, 48
    s_and_b32 s61, s7, 1
    s_lshl_b32 s61, s61, 3
    s_add_u32 s61, s61, 576
    v_cndmask_b32 v7, v2, v7, vcc
    v_lshl_add_u32 v0, v3, 3, s61
    v_lshlrev_b32 v4, 3, v3
    v_lshl_add_u32 v3, v14, 2, s61
    v_add_u32 v3, 64, v3
    v_cndmask_b32 v3, v2, v3, vcc
    s_mul_i32 s62, s62, 2304
    s_lshl_b32 s63, s60, 1
    s_add_u32 s62, s62, s63
    s_add_u32 s62, s62, 655360
    s_mul_i32 s58, s2, 2304
    s_add_u32 s58, s58, s63
    s_add_u32 s58, s58, 1245184
    s_mov_b64 s[40:41], s[32:33]
    s_mov_b32 s42, 0x10000000
    v_mov_b32 v15, 0xffffff00

    s_add_u32 s58, s62, 589824
    v_and_b32 v96, 1, v1
    v_mov_b32 v97, 0xffff
    v_lshlrev_b32 v96, 4, v96
    v_lshlrev_b32 v97, v96, v97
    v_bfe_u32 v98, v1, 1, 2

    v_cmp_eq_u32 vcc, 0, v98
    s_nop 1
    v_cndmask_b32 v124, 0, v97, vcc
    v_cmp_eq_u32 vcc, 1, v98
    s_nop 1
    v_cndmask_b32 v125, 0, v97, vcc
    v_cmp_eq_u32 vcc, 2, v98
    s_nop 1
    v_cndmask_b32 v126, 0, v97, vcc
    v_cmp_eq_u32 vcc, 3, v98
    s_nop 1
    v_cndmask_b32 v127, 0, v97, vcc
    s_getreg_b32 s0, hwreg(HW_REG_XCC_ID, 0, 4)
    s_movk_i32 s1, 256
    s_lshl_b32 s0, s0, 1
    s_waitcnt vmcnt(2)
    buffer_load_dwordx4 v[28:31], v5, s[36:39], s57 offen offset:0 nt
    s_waitcnt vmcnt(2)
    buffer_load_dwordx4 v[32:35], v5, s[36:39], s57 offen offset:128 nt
    s_waitcnt vmcnt(2)
    buffer_load_dwordx4 v[36:39], v5, s[36:39], s57 offen offset:256 nt
    s_movk_i32 s34, 16384
L_w_29:
    ds_read_b32 v2, v8 offset:4
    ds_read_b64 v[12:13], v6
    ds_read_b32 v14, v7
    s_waitcnt lgkmcnt(0)
    v_cmp_ne_u32 vcc, 1, v2
    s_sub_u32 s34, s34, 1
    s_cbranch_scc1 L_d_30
    s_cbranch_vccnz L_w_29
L_d_30:

    s_mul_i32 s72, s73, 1664525
    s_add_u32 s72, s72, 1013904223
    s_or_b32 s72, s72, 0x01010101
    s_xor_b32 s72, s72, s73
    s_and_b32 s68, s72, 0xff
    s_xor_b32 s68, s68, s0
    s_bfe_u32 s69, s72, 0x80008
    s_bfe_u32 s70, s72, 0x80010
    s_lshr_b32 s71, s72, 24
    v_and_b32 v96, v12, v124
    v_and_b32 v97, v12, v125
    v_and_b32 v98, v12, v126
    v_and_b32 v99, v12, v127
    v_and_b32 v100, v13, v124
    v_and_b32 v101, v13, v125
    v_and_b32 v102, v13, v126
    v_and_b32 v103, v13, v127
    v_and_b32 v104, v14, v124
    v_and_b32 v105, v14, v125
    v_and_b32 v106, v14, v126
    v_and_b32 v107, v14, v127
    s_nop 1
    v_mfma_f32_16x16x32_bf16 v[120:123], v[104:107], v[40:43], 0
    v_mfma_f32_16x16x32_bf16 v[108:111], v[96:99], v[16:19], 0
    v_mfma_f32_16x16x32_bf16 v[112:115], v[96:99], v[20:23], 0
    v_mfma_f32_16x16x32_bf16 v[116:119], v[96:99], v[24:27], 0
    s_waitcnt vmcnt(2)
    v_mfma_f32_16x16x32_bf16 v[108:111], v[100:103], v[28:31], v[108:111]
    s_waitcnt vmcnt(1)
    v_mfma_f32_16x16x32_bf16 v[112:115], v[100:103], v[32:35], v[112:115]
    s_waitcnt vmcnt(0)
    v_mfma_f32_16x16x32_bf16 v[116:119], v[100:103], v[36:39], v[116:119]
    s_nop 5
    v_permlane32_swap_b32 v108, v112
    v_permlane32_swap_b32 v109, v113
    v_permlane32_swap_b32 v110, v114
    v_permlane32_swap_b32 v111, v115
    v_add_f32_dpp v108, v112, v108 row_ror:8 row_mask:0xf bank_mask:0x3
    v_add_f32_dpp v109, v113, v109 row_ror:8 row_mask:0xf bank_mask:0x3
    v_add_f32_dpp v110, v114, v110 row_ror:8 row_mask:0xf bank_mask:0x3
    v_add_f32_dpp v111, v115, v111 row_ror:8 row_mask:0xf bank_mask:0x3
    v_mov_b32 v96, v116
    v_mov_b32 v97, v117
    v_mov_b32 v98, v118
    v_mov_b32 v99, v119
    v_permlane32_swap_b32 v116, v96
    v_permlane32_swap_b32 v117, v97
    v_permlane32_swap_b32 v118, v98
    v_permlane32_swap_b32 v119, v99
    v_add_f32_dpp v108, v116, v96 row_ror:8 row_mask:0xf bank_mask:0xc
    v_add_f32_dpp v109, v117, v97 row_ror:8 row_mask:0xf bank_mask:0xc
    v_add_f32_dpp v110, v118, v98 row_ror:8 row_mask:0xf bank_mask:0xc
    v_add_f32_dpp v111, v119, v99 row_ror:8 row_mask:0xf bank_mask:0xc
    v_add_f32 v108, v108, v120
    v_add_f32 v109, v109, v121
    v_add_f32 v110, v110, v122
    v_add_f32 v111, v111, v123
    v_and_or_b32 v108, v108, v15, s68
    v_and_or_b32 v109, v109, v15, s69
    v_and_or_b32 v110, v110, v15, s70
    v_and_or_b32 v111, v111, v15, s71
    buffer_store_dwordx4 v[108:111], v11, s[40:43], s62 offen
    s_xor_b32 s68, s68, s0
    s_waitcnt vmcnt(0)
    s_mov_b64 exec, 1
    ds_add_u32 v8, v10 offset:32
    s_mov_b64 exec, -1
    s_setprio 0
    s_movk_i32 s34, 16384
L_w_31:
    ds_read_b32 v2, v8 offset:112
    s_waitcnt lgkmcnt(0)
    v_cmp_gt_u32 vcc, 4, v2
    s_sub_u32 s34, s34, 1
    s_cbranch_scc1 L_d_32
    s_cbranch_vccnz L_w_31
L_d_32:

    s_setprio 2
    buffer_load_dwordx4 v[72:75], v9, s[44:47], s64 offen offset:0 nt
    buffer_load_dwordx4 v[76:79], v9, s[44:47], s64 offen offset:128 nt
    buffer_load_dwordx4 v[80:83], v9, s[44:47], s64 offen offset:256 nt
    buffer_load_dwordx4 v[84:87], v9, s[44:47], s64 offen offset:1152 nt
    buffer_load_dwordx4 v[88:91], v9, s[44:47], s64 offen offset:1280 nt
    buffer_load_dwordx4 v[92:95], v9, s[44:47], s64 offen offset:1408 nt
    s_waitcnt vmcnt(5)
    buffer_load_dwordx4 v[48:51], v9, s[48:51], s67 offen offset:0 nt
    s_waitcnt vmcnt(5)
    buffer_load_dwordx4 v[52:55], v9, s[48:51], s67 offen offset:128 nt
    s_waitcnt vmcnt(5)
    buffer_load_dwordx4 v[56:59], v9, s[48:51], s67 offen offset:256 nt
    s_waitcnt vmcnt(5)
    buffer_load_dwordx4 v[60:63], v9, s[48:51], s67 offen offset:1152 nt
    s_waitcnt vmcnt(5)
    buffer_load_dwordx4 v[64:67], v9, s[48:51], s67 offen offset:1280 nt
    s_waitcnt vmcnt(5)
    buffer_load_dwordx4 v[68:71], v9, s[48:51], s67 offen offset:1408 nt
    s_mov_b64 exec, 1
    ds_add_u32 v8, v10 offset:44
    s_mov_b64 exec, -1
    s_setprio 3
    s_movk_i32 s34, 16384
L_w_33:
    ds_read_b32 v2, v8 offset:16
    ds_read_b64 v[12:13], v0
    ds_read_b32 v14, v3
    s_waitcnt lgkmcnt(0)
    v_cmp_eq_u32 vcc, 0, v2
    s_sub_u32 s34, s34, 1
    s_cbranch_scc1 L_d_34
    s_cbranch_vccnz L_w_33
L_d_34:

    v_readfirstlane_b32 s59, v2
    v_and_b32 v96, v12, v124
    v_and_b32 v97, v12, v125
    v_and_b32 v98, v12, v126
    v_and_b32 v99, v12, v127
    v_and_b32 v100, v13, v124
    v_and_b32 v101, v13, v125
    v_and_b32 v102, v13, v126
    v_and_b32 v103, v13, v127
    v_and_b32 v104, v14, v124
    v_and_b32 v105, v14, v125
    v_and_b32 v106, v14, v126
    v_and_b32 v107, v14, v127
    s_nop 1
    v_mfma_f32_16x16x32_bf16 v[120:123], v[104:107], v[44:47], 0
    v_mfma_f32_16x16x32_bf16 v[108:111], v[96:99], v[72:75], 0
    v_mfma_f32_16x16x32_bf16 v[112:115], v[96:99], v[76:79], 0
    v_mfma_f32_16x16x32_bf16 v[116:119], v[96:99], v[80:83], 0
    v_mfma_f32_16x16x32_bf16 v[108:111], v[100:103], v[84:87], v[108:111]
    v_mfma_f32_16x16x32_bf16 v[112:115], v[100:103], v[88:91], v[112:115]
    v_mfma_f32_16x16x32_bf16 v[116:119], v[100:103], v[92:95], v[116:119]
    s_movk_i32 s34, 16384
L_w_35:
    ds_read_b32 v2, v8 offset:20
    ds_read_b64 v[12:13], v4 offset:512
    s_waitcnt lgkmcnt(0)
    v_cmp_ne_u32 vcc, 1, v2
    s_sub_u32 s34, s34, 1
    s_cbranch_scc1 L_d_36
    s_cbranch_vccnz L_w_35
L_d_36:

    v_and_b32 v96, v12, v124
    v_and_b32 v97, v12, v125
    v_and_b32 v98, v12, v126
    v_and_b32 v99, v12, v127
    v_and_b32 v100, v13, v124
    v_and_b32 v101, v13, v125
    v_and_b32 v102, v13, v126
    v_and_b32 v103, v13, v127
    s_waitcnt vmcnt(5)
    v_mfma_f32_16x16x32_bf16 v[108:111], v[96:99], v[48:51], v[108:111]
    s_waitcnt vmcnt(4)
    v_mfma_f32_16x16x32_bf16 v[112:115], v[96:99], v[52:55], v[112:115]
    s_waitcnt vmcnt(3)
    v_mfma_f32_16x16x32_bf16 v[116:119], v[96:99], v[56:59], v[116:119]
    s_waitcnt vmcnt(2)
    v_mfma_f32_16x16x32_bf16 v[108:111], v[100:103], v[60:63], v[108:111]
    s_waitcnt vmcnt(1)
    v_mfma_f32_16x16x32_bf16 v[112:115], v[100:103], v[64:67], v[112:115]
    s_waitcnt vmcnt(0)
    v_mfma_f32_16x16x32_bf16 v[116:119], v[100:103], v[68:71], v[116:119]
    s_nop 5
    v_permlane32_swap_b32 v108, v112
    v_permlane32_swap_b32 v109, v113
    v_permlane32_swap_b32 v110, v114
    v_permlane32_swap_b32 v111, v115
    v_add_f32_dpp v108, v112, v108 row_ror:8 row_mask:0xf bank_mask:0x3
    v_add_f32_dpp v109, v113, v109 row_ror:8 row_mask:0xf bank_mask:0x3
    v_add_f32_dpp v110, v114, v110 row_ror:8 row_mask:0xf bank_mask:0x3
    v_add_f32_dpp v111, v115, v111 row_ror:8 row_mask:0xf bank_mask:0x3
    s_cmp_lg_u32 s59, 1
    v_mov_b32 v96, v116
    v_mov_b32 v97, v117
    v_mov_b32 v98, v118
    v_mov_b32 v99, v119
    v_permlane32_swap_b32 v116, v96
    v_permlane32_swap_b32 v117, v97
    v_permlane32_swap_b32 v118, v98
    v_permlane32_swap_b32 v119, v99
    v_add_f32_dpp v108, v116, v96 row_ror:8 row_mask:0xf bank_mask:0xc
    v_add_f32_dpp v109, v117, v97 row_ror:8 row_mask:0xf bank_mask:0xc
    v_add_f32_dpp v110, v118, v98 row_ror:8 row_mask:0xf bank_mask:0xc
    v_add_f32_dpp v111, v119, v99 row_ror:8 row_mask:0xf bank_mask:0xc
    v_add_f32 v108, v108, v120
    v_add_f32 v109, v109, v121
    v_add_f32 v110, v110, v122
    v_add_f32 v111, v111, v123
    v_and_or_b32 v108, v108, v15, s68
    v_and_or_b32 v109, v109, v15, s69
    v_and_or_b32 v110, v110, v15, s70
    v_and_or_b32 v111, v111, v15, s71
    s_cbranch_scc1 L_pubslow
    buffer_store_dwordx4 v[108:111], v11, s[40:43], s58 offen
    s_branch L_pubdone
L_pubslow:
    buffer_store_dwordx4 v[108:111], v11, s[40:43], s58 offen sc1
L_pubdone:
    s_mov_b64 exec, 1
    ds_add_u32 v8, v10 offset:28
    s_mov_b64 exec, -1
    s_endpgm
L_Rbody:
    s_mul_i32 s64, s7, 9
    s_lshr_b32 s64, s64, 1
    s_mul_i32 s66, s6, 1152
    s_lshl3_add_u32 s58, s64, s66
    s_mul_i32 s56, s6, 73728
    s_lshl4_add_u32 s56, s64, s56
    s_add_u32 s56, s56, 655360
    s_add_u32 s57, s56, 18432
    s_add_u32 s60, s56, 36864
    s_add_u32 s61, s56, 55296
    v_mul_u32_u24 v5, 2304, v4
    v_lshl_add_u32 v5, v3, 4, v5
    v_bfe_u32 v6, v1, 2, 1
    v_and_b32 v7, 2, v1
    v_or_b32 v6, v6, v7
    v_lshl_or_b32 v6, v3, 2, v6
    v_lshlrev_b32 v7, 2, v6
    v_lshlrev_b32 v6, 1, v6
    s_mul_i32 s64, s6, 18
    s_add_u32 s64, s64, s7
    v_lshrrev_b32 v8, 4, v1
    v_and_b32 v9, 1, v8
    v_lshrrev_b32 v8, 1, v8
    v_lshl_or_b32 v8, v9, 1, v8
    v_lshlrev_b32 v8, 1, v8
    v_lshl_or_b32 v8, v4, 3, v8
    s_lshl_b32 s59, s7, 6
    s_movk_i32 s46, 9216
    s_mov_b32 s47, 0x20000
    s_movk_i32 s50, 1152
    s_mov_b32 s51, 0x20000
    s_movk_i32 s54, 1152
    s_mov_b32 s55, 0x20000
    s_movk_i32 s38, 1152
    s_mov_b32 s42, 0x10000000
    s_waitcnt lgkmcnt(0)
    s_load_dword s73, s[32:33], 0
    s_mov_b64 s[44:45], s[22:23]
    s_mov_b64 s[48:49], s[8:9]
    s_mov_b64 s[52:53], s[26:27]
    s_mov_b64 s[36:37], s[28:29]
    s_mov_b64 s[40:41], s[32:33]

    buffer_load_ushort v9, v6, s[44:47], s58 offen
    buffer_load_ushort v10, v8, s[48:51], s59 offen
    buffer_load_ushort v11, v8, s[52:55], s59 offen
    buffer_load_ushort v12, v8, s[36:39], s59 offen sc1
    s_barrier
    s_mov_b32 s62, 0xcccccccc
    s_mov_b32 s63, 0xcccccccc
    s_mov_b32 s65, 0
    s_movk_i32 s66, 8
    s_mov_b32 s8, -1
    s_movk_i32 s9, 0xff
    s_waitcnt lgkmcnt(0)

    s_getreg_b32 s0, hwreg(HW_REG_XCC_ID, 0, 4)
    s_movk_i32 s1, 256
    s_lshl_b32 s0, s0, 1
    v_mov_b32 v100, -1
    s_mul_i32 s72, s73, 1664525
    s_add_u32 s72, s72, 1013904223
    s_or_b32 s72, s72, 0x01010101
    s_xor_b32 s72, s72, s73
    s_and_b32 s68, s72, 0xff
    s_xor_b32 s68, s68, s0
    s_bfe_u32 s69, s72, 0x80008
    s_bfe_u32 s70, s72, 0x80010
    s_lshr_b32 s71, s72, 24
    v_mov_b32 v98, 0xc0135761
    v_mov_b32 v99, 0xbdd2d3e8
    s_waitcnt vmcnt(0)
    v_mov_b32 v14, 0
    v_mov_b32 v15, 1
    v_lshlrev_b32 v9, 16, v9
    v_lshlrev_b32 v10, 16, v10
    v_lshlrev_b32 v11, 16, v11
    v_add_f32 v10, v10, v11
    v_mov_b32 v12, s72
    v_mov_b32 v13, 112
    s_mov_b32 s67, 4
    s_movk_i32 s58, 32
    s_mov_b32 s35, 0
L_Rgather:
    v_add_u32 v101, s35, v5
    v_add_u32 v102, s35, v101
    v_add_u32 v103, s35, v102
    s_mov_b64 s[10:11], s[8:9]
    s_mov_b64 s[12:13], s[8:9]
    s_mov_b64 s[14:15], s[8:9]

    v_not_b32 v32, s68
    v_not_b32 v36, s68
    v_not_b32 v40, s68
    v_not_b32 v44, s68
    v_not_b32 v48, s68
    v_not_b32 v52, s68
    v_not_b32 v56, s68
    v_not_b32 v60, s68
    v_not_b32 v64, s68
    v_not_b32 v68, s68
    v_not_b32 v72, s68
    v_not_b32 v76, s68
    v_not_b32 v80, s68
    v_not_b32 v84, s68
    v_not_b32 v88, s68
    v_not_b32 v92, s68
    s_movk_i32 s34, 16384
L_w_37:
    ds_read_b32 v11, v13 offset:0
    s_waitcnt lgkmcnt(0)
    v_cmp_gt_u32 vcc, s67, v11
    s_sub_u32 s34, s34, 1
    s_cbranch_scc1 L_d_38
    s_cbranch_vccnz L_w_37
L_d_38:

    s_setprio 3
    s_mov_b32 s34, s58
L_gs_40:
    s_waitcnt vmcnt(0)
L_g0_41:
    s_waitcnt vmcnt(15)
    s_mov_b64 exec, s[8:9]
    v_bitop3_b32 v16, s68, v32, v100 bitop3:0x28
    v_xor_b32 v17, s69, v33
    v_xor_b32 v18, s70, v34
    v_xor_b32 v19, s71, v35
    v_or3_b32 v96, v16, v17, v18
    v_or_b32 v96, v96, v19
    v_cmp_ne_u32_sdwa s[8:9], v96, 0 src0_sel:BYTE_0 src1_sel:DWORD

    s_or_b64 exec, s[8:9], 1
    buffer_load_dwordx4 v[32:35], v5, s[40:43], s56 offen sc1
    s_waitcnt vmcnt(15)
    s_mov_b64 exec, s[10:11]
    v_bitop3_b32 v20, s68, v36, v100 bitop3:0x28
    v_xor_b32 v21, s69, v37
    v_xor_b32 v22, s70, v38
    v_xor_b32 v23, s71, v39
    v_or3_b32 v96, v20, v21, v22
    v_or_b32 v96, v96, v23
    v_cmp_ne_u32_sdwa s[10:11], v96, 0 src0_sel:BYTE_0 src1_sel:DWORD

    s_or_b64 exec, s[10:11], 1
    buffer_load_dwordx4 v[36:39], v5, s[40:43], s57 offen sc1
    s_waitcnt vmcnt(15)
    s_mov_b64 exec, s[12:13]
    v_bitop3_b32 v24, s68, v40, v100 bitop3:0x28
    v_xor_b32 v25, s69, v41
    v_xor_b32 v26, s70, v42
    v_xor_b32 v27, s71, v43
    v_or3_b32 v96, v24, v25, v26
    v_or_b32 v96, v96, v27
    v_cmp_ne_u32_sdwa s[12:13], v96, 0 src0_sel:BYTE_0 src1_sel:DWORD

    s_or_b64 exec, s[12:13], 1
    buffer_load_dwordx4 v[40:43], v5, s[40:43], s60 offen sc1
    s_waitcnt vmcnt(15)
    s_mov_b64 exec, s[14:15]
    v_bitop3_b32 v28, s68, v44, v100 bitop3:0x28
    v_xor_b32 v29, s69, v45
    v_xor_b32 v30, s70, v46
    v_xor_b32 v31, s71, v47
    v_or3_b32 v96, v28, v29, v30
    v_or_b32 v96, v96, v31
    v_cmp_ne_u32_sdwa s[14:15], v96, 0 src0_sel:BYTE_0 src1_sel:DWORD

    s_or_b64 exec, s[14:15], 1
    buffer_load_dwordx4 v[44:47], v5, s[40:43], s61 offen sc1
    s_or_b64 s[16:17], s[8:9], s[10:11]
    s_or_b64 s[18:19], s[12:13], s[14:15]
    s_or_b64 s[16:17], s[16:17], s[18:19]
    s_cbranch_scc0 L_gd_39

    s_sub_u32 s34, s34, 1
    s_cbranch_scc1 L_fb_42
    s_bcnt1_i32_b64 s35, s[16:17]
    s_cmp_gt_u32 s35, s66
    s_cbranch_scc1 L_gs_40
    s_waitcnt vmcnt(15)
    s_mov_b64 exec, s[8:9]
    v_bitop3_b32 v16, s68, v48, v100 bitop3:0x28
    v_xor_b32 v17, s69, v49
    v_xor_b32 v18, s70, v50
    v_xor_b32 v19, s71, v51
    v_or3_b32 v96, v16, v17, v18
    v_or_b32 v96, v96, v19
    v_cmp_ne_u32_sdwa s[8:9], v96, 0 src0_sel:BYTE_0 src1_sel:DWORD

    s_or_b64 exec, s[8:9], 1
    buffer_load_dwordx4 v[48:51], v5, s[40:43], s56 offen sc1
    s_waitcnt vmcnt(15)
    s_mov_b64 exec, s[10:11]
    v_bitop3_b32 v20, s68, v52, v100 bitop3:0x28
    v_xor_b32 v21, s69, v53
    v_xor_b32 v22, s70, v54
    v_xor_b32 v23, s71, v55
    v_or3_b32 v96, v20, v21, v22
    v_or_b32 v96, v96, v23
    v_cmp_ne_u32_sdwa s[10:11], v96, 0 src0_sel:BYTE_0 src1_sel:DWORD

    s_or_b64 exec, s[10:11], 1
    buffer_load_dwordx4 v[52:55], v5, s[40:43], s57 offen sc1
    s_waitcnt vmcnt(15)
    s_mov_b64 exec, s[12:13]
    v_bitop3_b32 v24, s68, v56, v100 bitop3:0x28
    v_xor_b32 v25, s69, v57
    v_xor_b32 v26, s70, v58
    v_xor_b32 v27, s71, v59
    v_or3_b32 v96, v24, v25, v26
    v_or_b32 v96, v96, v27
    v_cmp_ne_u32_sdwa s[12:13], v96, 0 src0_sel:BYTE_0 src1_sel:DWORD

    s_or_b64 exec, s[12:13], 1
    buffer_load_dwordx4 v[56:59], v5, s[40:43], s60 offen sc1
    s_waitcnt vmcnt(15)
    s_mov_b64 exec, s[14:15]
    v_bitop3_b32 v28, s68, v60, v100 bitop3:0x28
    v_xor_b32 v29, s69, v61
    v_xor_b32 v30, s70, v62
    v_xor_b32 v31, s71, v63
    v_or3_b32 v96, v28, v29, v30
    v_or_b32 v96, v96, v31
    v_cmp_ne_u32_sdwa s[14:15], v96, 0 src0_sel:BYTE_0 src1_sel:DWORD

    s_or_b64 exec, s[14:15], 1
    buffer_load_dwordx4 v[60:63], v5, s[40:43], s61 offen sc1
    s_or_b64 s[16:17], s[8:9], s[10:11]
    s_or_b64 s[18:19], s[12:13], s[14:15]
    s_or_b64 s[16:17], s[16:17], s[18:19]
    s_cbranch_scc0 L_gd_39

    s_waitcnt vmcnt(15)
    s_mov_b64 exec, s[8:9]
    v_bitop3_b32 v16, s68, v64, v100 bitop3:0x28
    v_xor_b32 v17, s69, v65
    v_xor_b32 v18, s70, v66
    v_xor_b32 v19, s71, v67
    v_or3_b32 v96, v16, v17, v18
    v_or_b32 v96, v96, v19
    v_cmp_ne_u32_sdwa s[8:9], v96, 0 src0_sel:BYTE_0 src1_sel:DWORD

    s_or_b64 exec, s[8:9], 1
    buffer_load_dwordx4 v[64:67], v5, s[40:43], s56 offen sc1
    s_waitcnt vmcnt(15)
    s_mov_b64 exec, s[10:11]
    v_bitop3_b32 v20, s68, v68, v100 bitop3:0x28
    v_xor_b32 v21, s69, v69
    v_xor_b32 v22, s70, v70
    v_xor_b32 v23, s71, v71
    v_or3_b32 v96, v20, v21, v22
    v_or_b32 v96, v96, v23
    v_cmp_ne_u32_sdwa s[10:11], v96, 0 src0_sel:BYTE_0 src1_sel:DWORD

    s_or_b64 exec, s[10:11], 1
    buffer_load_dwordx4 v[68:71], v5, s[40:43], s57 offen sc1
    s_waitcnt vmcnt(15)
    s_mov_b64 exec, s[12:13]
    v_bitop3_b32 v24, s68, v72, v100 bitop3:0x28
    v_xor_b32 v25, s69, v73
    v_xor_b32 v26, s70, v74
    v_xor_b32 v27, s71, v75
    v_or3_b32 v96, v24, v25, v26
    v_or_b32 v96, v96, v27
    v_cmp_ne_u32_sdwa s[12:13], v96, 0 src0_sel:BYTE_0 src1_sel:DWORD

    s_or_b64 exec, s[12:13], 1
    buffer_load_dwordx4 v[72:75], v5, s[40:43], s60 offen sc1
    s_waitcnt vmcnt(15)
    s_mov_b64 exec, s[14:15]
    v_bitop3_b32 v28, s68, v76, v100 bitop3:0x28
    v_xor_b32 v29, s69, v77
    v_xor_b32 v30, s70, v78
    v_xor_b32 v31, s71, v79
    v_or3_b32 v96, v28, v29, v30
    v_or_b32 v96, v96, v31
    v_cmp_ne_u32_sdwa s[14:15], v96, 0 src0_sel:BYTE_0 src1_sel:DWORD

    s_or_b64 exec, s[14:15], 1
    buffer_load_dwordx4 v[76:79], v5, s[40:43], s61 offen sc1
    s_or_b64 s[16:17], s[8:9], s[10:11]
    s_or_b64 s[18:19], s[12:13], s[14:15]
    s_or_b64 s[16:17], s[16:17], s[18:19]
    s_cbranch_scc0 L_gd_39

    s_waitcnt vmcnt(15)
    s_mov_b64 exec, s[8:9]
    v_bitop3_b32 v16, s68, v80, v100 bitop3:0x28
    v_xor_b32 v17, s69, v81
    v_xor_b32 v18, s70, v82
    v_xor_b32 v19, s71, v83
    v_or3_b32 v96, v16, v17, v18
    v_or_b32 v96, v96, v19
    v_cmp_ne_u32_sdwa s[8:9], v96, 0 src0_sel:BYTE_0 src1_sel:DWORD

    s_or_b64 exec, s[8:9], 1
    buffer_load_dwordx4 v[80:83], v5, s[40:43], s56 offen sc1
    s_waitcnt vmcnt(15)
    s_mov_b64 exec, s[10:11]
    v_bitop3_b32 v20, s68, v84, v100 bitop3:0x28
    v_xor_b32 v21, s69, v85
    v_xor_b32 v22, s70, v86
    v_xor_b32 v23, s71, v87
    v_or3_b32 v96, v20, v21, v22
    v_or_b32 v96, v96, v23
    v_cmp_ne_u32_sdwa s[10:11], v96, 0 src0_sel:BYTE_0 src1_sel:DWORD

    s_or_b64 exec, s[10:11], 1
    buffer_load_dwordx4 v[84:87], v5, s[40:43], s57 offen sc1
    s_waitcnt vmcnt(15)
    s_mov_b64 exec, s[12:13]
    v_bitop3_b32 v24, s68, v88, v100 bitop3:0x28
    v_xor_b32 v25, s69, v89
    v_xor_b32 v26, s70, v90
    v_xor_b32 v27, s71, v91
    v_or3_b32 v96, v24, v25, v26
    v_or_b32 v96, v96, v27
    v_cmp_ne_u32_sdwa s[12:13], v96, 0 src0_sel:BYTE_0 src1_sel:DWORD

    s_or_b64 exec, s[12:13], 1
    buffer_load_dwordx4 v[88:91], v5, s[40:43], s60 offen sc1
    s_waitcnt vmcnt(15)
    s_mov_b64 exec, s[14:15]
    v_bitop3_b32 v28, s68, v92, v100 bitop3:0x28
    v_xor_b32 v29, s69, v93
    v_xor_b32 v30, s70, v94
    v_xor_b32 v31, s71, v95
    v_or3_b32 v96, v28, v29, v30
    v_or_b32 v96, v96, v31
    v_cmp_ne_u32_sdwa s[14:15], v96, 0 src0_sel:BYTE_0 src1_sel:DWORD

    s_or_b64 exec, s[14:15], 1
    buffer_load_dwordx4 v[92:95], v5, s[40:43], s61 offen sc1
    s_or_b64 s[16:17], s[8:9], s[10:11]
    s_or_b64 s[18:19], s[12:13], s[14:15]
    s_or_b64 s[16:17], s[16:17], s[18:19]
    s_cbranch_scc0 L_gd_39

    s_branch L_g0_41
L_fb_42:
    s_mov_b64 exec, -1
    s_sub_u32 s1, s1, 1
    s_cbranch_scc1 L_gd_39
    s_waitcnt vmcnt(0)
    s_movk_i32 s34, 16384
L_w_43:
    ds_read_b32 v11, v14 offset:32
    s_waitcnt lgkmcnt(0)
    v_cmp_gt_u32 vcc, 3, v11
    s_sub_u32 s34, s34, 1
    s_cbranch_scc1 L_d_44
    s_cbranch_vccnz L_w_43
L_d_44:

    v_mov_b32 v15, 2
    buffer_wbl2 sc1
    s_waitcnt vmcnt(0)
    buffer_inv sc1
    s_waitcnt vmcnt(0)
    v_mov_b32 v100, 0xffffffe1
    s_mov_b32 s34, 1
    s_branch L_g0_41

L_gd_39:
    s_mov_b64 exec, -1
    v_pk_add_f32 v[16:17], v[16:17], v[20:21]
    v_pk_add_f32 v[24:25], v[24:25], v[28:29]
    v_pk_add_f32 v[18:19], v[18:19], v[22:23]
    v_pk_add_f32 v[26:27], v[26:27], v[30:31]
    v_pk_add_f32 v[16:17], v[16:17], v[24:25]
    v_pk_add_f32 v[18:19], v[18:19], v[26:27]
    s_cmp_lg_u32 s65, 0

    s_cbranch_scc1 L_Rfinal
    v_add_f32_dpp v16, v16, v16 row_half_mirror row_mask:0xf bank_mask:0x5
    v_add_f32_dpp v18, v18, v18 row_half_mirror row_mask:0xf bank_mask:0x5
    s_nop 0
    v_add_f32_dpp v16, v17, v17 row_half_mirror row_mask:0xf bank_mask:0xa
    v_add_f32_dpp v18, v19, v19 row_half_mirror row_mask:0xf bank_mask:0xa
    s_nop 0
    v_add_f32_dpp v16, v16, v16 quad_perm:[2,3,0,1] row_mask:0xf bank_mask:0xf
    v_add_f32_dpp v18, v18, v18 quad_perm:[2,3,0,1] row_mask:0xf bank_mask:0xf
    v_cndmask_b32 v16, v16, v18, s[62:63]
    s_nop 1
    v_add_f32_dpp v16, v16, v16 quad_perm:[1,0,3,2] row_mask:0xf bank_mask:0xf
    s_nop 0
    s_nop 0
    v_cvt_pk_bf16_f32 v16, 0, v16
    v_add_f32 v16, v16, v9
    v_cvt_pk_bf16_f32 v16, 0, v16
    v_mul_f32 v17, v16, v16
    v_fma_f32 v17, v17, v99, v98
    v_mul_f32 v17, v17, v16
    v_exp_f32 v17, v17
    s_nop 0
    v_add_f32 v17, 1.0, v17
    v_rcp_f32 v17, v17
    s_mov_b32 exec_hi, 0xff
    v_mul_f32 v16, v16, v17
    v_cvt_pk_bf16_f32 v16, v16, v16
    ds_write_b32 v7, v16 offset:576
    ds_write_b32 v14, v15 offset:16
    s_mov_b64 exec, -1

    s_cmpk_lt_u32 s2, 144
    s_cbranch_scc0 L_Rfin
    s_setprio 0

    s_mul_i32 s56, s6, 73728
    s_lshl_b32 s57, s7, 7
    s_add_u32 s56, s56, s57
    s_add_u32 s56, s56, 1245184
    s_add_u32 s57, s56, 18432
    s_add_u32 s60, s56, 36864
    s_add_u32 s61, s56, 55296
    s_lshl_b32 s44, s7, 10
    s_add_u32 s44, s44, 32768
    s_lshl_b32 s45, s6, 7
    s_add_u32 s45, s45, s44
    s_mov_b32 s46, 0x55555555
    s_mov_b32 s47, 0x55555555
    s_mov_b32 s48, 0x00ff00ff
    s_mov_b32 s49, 0x00ff00ff
    s_and_b32 s50, s7, 7
    v_lshlrev_b32 v7, 1, v8
    v_mul_u32_u24 v5, 2304, v3
    v_lshl_add_u32 v5, v4, 4, v5
    s_mov_b64 s[46:47], s[48:49]
    v_lshlrev_b32 v9, 1, v7
    v_bfe_u32 v97, v12, v9, 8
    v_mov_b32 v9, 0xffffff00
    s_mov_b32 s65, 1
    s_movk_i32 s66, 64
    s_mov_b64 s[8:9], -1
    v_mov_b32 v13, 28
    s_mov_b32 s67, 3
    s_movk_i32 s58, 8192
    s_xor_b32 s68, s68, s0
    s_xor_b32 s69, s69, 0
    s_mov_b32 s1, 0
    v_mov_b32 v100, -1
    s_mov_b64 exec, 0
    s_cmp_lg_u32 s65, s65
    s_cbranch_scc0 L_Rfinal
L_Rdry:
    s_mov_b64 exec, -1
    s_waitcnt vmcnt(0)
    s_branch L_Rgather
L_Rst1:
    v_and_or_b32 v16, v16, v9, v97
    s_mov_b64 exec, s[46:47]
    buffer_store_dword v16, v7, s[40:43], s45 offen sc1
    s_mov_b64 exec, -1
    s_nop 0
    s_cmp_lg_u32 s50, s6
    s_cbranch_scc1 L_Rfin3
    s_mov_b64 s[8:9], -1
    s_mov_b64 s[62:63], s[48:49]
    s_xor_b32 s69, s69, 0
    s_mov_b32 s1, 0

    buffer_load_dwordx4 v[104:107], v2, s[40:43], s44 offen sc1
    s_mov_b32 s34, 8192
L_gs_46:
    s_waitcnt vmcnt(0)
L_g0_47:
    s_mov_b64 exec, s[8:9]
    v_bitop3_b32 v16, s68, v104, v100 bitop3:0x28
    v_xor_b32 v17, s69, v105
    v_xor_b32 v18, s70, v106
    v_xor_b32 v19, s71, v107
    v_or3_b32 v96, v16, v17, v18
    v_or_b32 v96, v96, v19
    v_cmp_ne_u32_sdwa s[8:9], v96, 0 src0_sel:BYTE_0 src1_sel:DWORD

    s_cmp_eq_u64 s[8:9], 0
    s_cbranch_scc1 L_fd_45
    s_mov_b64 exec, s[8:9]
    buffer_load_dwordx4 v[104:107], v2, s[40:43], s44 offen sc1
    s_sub_u32 s34, s34, 1
    s_cbranch_scc1 L_fb_48
    s_branch L_gs_46
L_fb_48:
    s_mov_b64 exec, -1
    s_sub_u32 s1, s1, 1
    s_cbranch_scc1 L_fd_45
    s_waitcnt vmcnt(0)
    buffer_wbl2 sc1
    s_waitcnt vmcnt(0)
    buffer_inv sc1
    s_waitcnt vmcnt(0)
    v_mov_b32 v100, 0xffffffe1
    s_mov_b32 s34, 1
    s_branch L_g0_47

L_fd_45:
    s_mov_b64 exec, -1
    s_cmp_lg_u32 s65, s65

L_Rfinal:
    v_permlane32_swap_b32 v16, v17
    v_permlane32_swap_b32 v18, v19
    v_add_f32 v16, v16, v17
    v_add_f32 v18, v18, v19
    s_nop 1
    v_permlane16_swap_b32 v16, v18
    v_add_f32 v16, v16, v18

    s_nop 1
    v_add_f32_dpp v16, v16, v16 row_ror:8 row_mask:0xf bank_mask:0xf
    s_cbranch_scc1 L_Rst1
    v_add_f32 v16, v16, v10
    v_cvt_pk_bf16_f32 v16, v16, v16
    s_cbranch_execz L_Rdry
    s_mov_b64 exec, s[62:63]
    buffer_store_short v16, v8, s[36:39], s59 offen sc1
    s_cmp_lg_u32 s2, 0
    s_cbranch_scc1 L_Rfin2
    s_mov_b64 exec, 1
    buffer_store_dword v12, off, s[40:43], 0 sc1
L_Rfin2:

    s_endpgm
L_Rfin3:
    s_endpgm
L_Rfin:
L_end:
    s_endpgm
L_codeend:

.section .rodata,"a"
.p2align 6
.amdhsa_kernel parallel_sum__sliding_block_cached__mixer_channel_mlp__decode_kernel
  .amdhsa_next_free_vgpr 128
  .amdhsa_next_free_sgpr 96
  .amdhsa_accum_offset 128
  .amdhsa_group_segment_fixed_size 0
  .amdhsa_kernarg_size 104
  .amdhsa_user_sgpr_count 2
  .amdhsa_user_sgpr_kernarg_segment_ptr 1
  .amdhsa_system_sgpr_workgroup_id_x 1
.end_amdhsa_kernel
```
